```python
import torch

def _softmax(x, axis=-1):
    return torch.softmax(x, dim=axis)
def _gelu(x):
    return torch.nn.functional.gelu(x, approximate="tanh")
def _silu(x):
    return torch.nn.functional.silu(x)
def _sigmoid(x):
    return torch.sigmoid(x)
def _layernorm(x, axis=-1, eps=1e-5):
    m = x.mean(dim=axis, keepdim=True)
    v = x.var(dim=axis, keepdim=True, unbiased=False)
    return (x - m) / torch.sqrt(v + eps)
def _scatter_add(tgt, idx, src, axis=0):
    return tgt.clone().index_add_(axis, idx, src)
def _segment_sum(src, seg, n):
    out = torch.zeros((n,) + src.shape[1:], dtype=src.dtype)
    return out.index_add_(0, seg, src)
def _pad(x, pw):
    flat = tuple(v for pair in reversed(pw) for v in pair)
    return torch.nn.functional.pad(x, flat)

kernel_name = 'parallel_sum__gqa_block_cached__dense_activation_gelu__decode'

def setup_inputs():

    _w = (lambda a: (lambda t: t.to(torch.bfloat16) if t.is_floating_point() else t)(torch.as_tensor(a)))
    def _A_setup():
        B, Sq, D = 1, 1, 448
        Hq, Hkv, Sk, Dh = 16, 8, 65536, 256
        assert Hq % Hkv == 0, (Hq, Hkv)
        return {
            "x": _w((lambda *s: torch.randn(*s, dtype=torch.bfloat16) * 0.05)(B, Sq, D)),
            "k_cache": _w((lambda *s: torch.randn(*s, dtype=torch.bfloat16) * 3.2)(B, Hkv, Sk, Dh)),
            "v_cache": _w((lambda *s: torch.randn(*s, dtype=torch.bfloat16) * 1.6)(B, Hkv, Sk, Dh)),
            "wq": _w((lambda *s: torch.randn(*s, dtype=torch.bfloat16) * 3.2)(D, Hq * Dh) * (D ** -0.5)),
            "wo": _w((lambda *s: torch.randn(*s, dtype=torch.bfloat16) * 1.6)(Hq * Dh, D) * ((Hq * Dh) ** -0.5)),
        }
    _A_in = _A_setup()

    def _B_setup():
        B, S, D, F = 1, 1, 448, 1792
        return {
            "x": _w((lambda *s: torch.randn(*s, dtype=torch.bfloat16) * 0.05)(B, S, D)),
            "w1": _w((lambda *s: torch.randn(*s, dtype=torch.bfloat16) * 1.6)(D, F) * (D ** -0.5)),
            "b1": _w((lambda *s: torch.randn(*s, dtype=torch.bfloat16) * 1.6)(F) * 0.01),
            "w2": _w((lambda *s: torch.randn(*s, dtype=torch.bfloat16) * 1.6)(F, D) * (F ** -0.5)),
            "b2": _w((lambda *s: torch.randn(*s, dtype=torch.bfloat16) * 1.6)(D) * 0.01),
        }
    _B_in = _B_setup()

    return {
        "A_x": _A_in["x"],
        "A_k_cache": _A_in["k_cache"],
        "A_v_cache": _A_in["v_cache"],
        "A_wq": _A_in["wq"],
        "A_wo": _A_in["wo"],
        "B_x": _B_in["x"],
        "B_w1": _B_in["w1"],
        "B_b1": _B_in["b1"],
        "B_w2": _B_in["w2"],
        "B_b2": _B_in["b2"],
    }

def reference(A_x, A_k_cache, A_v_cache, A_wq, A_wo, B_x, B_w1, B_b1, B_w2, B_b2):
    def _A_ref(x, k_cache, v_cache, wq, wo):
        B, Sq, D = x.shape
        Hq, Dh = 16, 256
        Hkv = k_cache.shape[1]
        rep = Hq // Hkv
        q = (lambda x, *d: x.permute(*d))((x @ wq).reshape(B, Sq, Hq, Dh), 0, 2, 1, 3)
        k = (lambda x, n, axis: torch.repeat_interleave(x, n, dim=axis))(k_cache, rep, axis=1)
        v = (lambda x, n, axis: torch.repeat_interleave(x, n, dim=axis))(v_cache, rep, axis=1)
        scores = torch.einsum("bhqd,bhkd->bhqk", q, k) * (Dh ** -0.5)
        p = _softmax(scores, axis=-1)
        o = torch.einsum("bhqk,bhkd->bhqd", p, v)
        return (lambda x, *d: x.permute(*d))(o, 0, 2, 1, 3).reshape(B, Sq, Hq * Dh) @ wo

    def _B_ref(x, w1, b1, w2, b2):
        h = torch.einsum("bsd,df->bsf", x, w1) + b1
        h = _gelu(h)
        return torch.einsum("bsf,fd->bsd", h, w2) + b2

    x = A_x
    xn = _layernorm(x, axis=-1)
    return x + _A_ref(xn, A_k_cache, A_v_cache, A_wq, A_wo) + _B_ref(xn, B_w1, B_b1, B_w2, B_b2)
```

```asm
; @launch grid=(256,1,1) block=(448,1,1) lds=32768
.amdgcn_target "amdgcn-amd-amdhsa--gfx950"
.text
.globl parallel_sum__gqa_block_cached__dense_activation_gelu__decode_kernel
.p2align 8
.type parallel_sum__gqa_block_cached__dense_activation_gelu__decode_kernel,@function
parallel_sum__gqa_block_cached__dense_activation_gelu__decode_kernel:
    s_cmp_ge_u32 s2, 256
    s_cbranch_scc1 L_end
    v_lshlrev_b32 v2, 2, v0
    v_and_b32 v2, 63, v2
    v_mov_b32 v3, 0
    ds_write_b32 v2, v3
    s_waitcnt lgkmcnt(0)
    s_load_dwordx16 s[16:31], s[0:1], 0
    s_load_dwordx8 s[32:39], s[0:1], 64
    s_load_dwordx2 s[40:41], s[0:1], 96
    v_lshrrev_b32 v2, 6, v0
    v_and_b32 v1, 63, v0
    v_readfirstlane_b32 s3, v2
    s_lshr_b32 s4, s2, 5
    s_and_b32 s5, s2, 7
    s_bfe_u32 s6, s2, 0x20003
    s_and_b32 s7, s2, 31
    v_lshlrev_b32 v4, 4, v1
    s_mov_b32 s51, 16384
    s_barrier
    s_cmp_lt_u32 s3, 4
    s_cbranch_scc1 L_stream
    s_cmp_eq_u32 s3, 4
    s_cbranch_scc1 L_helper
    s_cmp_eq_u32 s3, 6
    s_cbranch_scc1 L_qwave
    s_memrealtime s[70:71]
    s_getreg_b32 s11, hwreg(HW_REG_XCC_ID)
    s_bfe_u32 s10, s11, 0x10002
    s_xor_b32 s61, s10, s6
    s_and_b32 s61, s61, 1
    s_lshl_b32 s64, s61, 13
    s_xor_b32 s61, s6, s4
    s_and_b32 s61, s61, 2
    s_lshl_b32 s61, s61, 13
    s_or_b32 s64, s64, s61
    s_or_b32 s64, s64, 0x1000000
    s_lshl_b32 s60, s4, 25
    v_lshlrev_b32 v27, 7, v1
    s_lshl_b32 s66, s2, 7
    s_add_u32 s66, s66, 262144
    s_bitcmp1_b32 s2, 6
    s_waitcnt lgkmcnt(0)
    s_cselect_b32 s62, s20, s18
    s_cselect_b32 s63, s21, s19
    s_add_u32 s62, s62, s60
    s_addc_u32 s63, s63, 0
    s_add_u32 s70, s70, s2
    s_mul_i32 s70, s70, 0x9e3779b1
    s_lshr_b32 s70, s70, 4
    s_and_b32 s70, s70, 0xc79f80
    s_or_b32 s64, s64, s70
    s_xor_b32 s67, s64, 0x4000
    s_mov_b32 s52, s40
    s_mov_b32 s53, s41
    s_mov_b32 s54, 16777216
    s_mov_b32 s55, 0x00020000
    buffer_load_dword v31, off, s[52:55], s51 sc0 sc1
    s_cmp_ge_u32 s2, 128
    s_cbranch_scc1 L_novote
.p2align 6
    s_memtime s[70:71]
    s_load_dword s65, s[62:63], s64
    s_waitcnt lgkmcnt(0)
    s_memtime s[72:73]
    s_load_dword s65, s[62:63], s67
    s_waitcnt lgkmcnt(0)
    s_memtime s[74:75]
    s_sub_u32 s70, s72, s70
    s_min_u32 s70, s70, 1800
    s_waitcnt lgkmcnt(0)
    s_sub_u32 s72, s74, s72
    s_min_u32 s72, s72, 1800
    s_add_u32 s74, s70, s72
    s_sub_u32 s75, 0, s74
    s_bitcmp1_b32 s6, 0
    s_cselect_b32 s74, s75, s74
    s_lshl_b32 s74, s74, 1
    s_or_b32 s74, s74, s10
    s_sub_u32 s70, s70, s72
    s_sub_u32 s72, 0, s70
    s_bitcmp1_b32 s6, 1
    s_cselect_b32 s71, s72, s70
    s_cselect_b32 s72, s70, s72
    s_bitcmp1_b32 s11, 0
    s_cselect_b32 s72, s71, s72
    s_bitcmp1_b32 s6, 0
    s_cselect_b32 s70, s72, s71
    s_cselect_b32 s71, s71, s72
    s_pack_ll_b32_b16 s70, s70, s71
    s_waitcnt vmcnt(0)
    v_readfirstlane_b32 s50, v31
    s_nop 0
    s_and_b32 s50, s50, -4
    s_mul_i32 s50, s50, 0x2c9277b5
    s_add_u32 s50, s50, 0x3c6ef35c
    v_mov_b32 v28, s74
    v_mov_b32 v29, s50
    v_mov_b32 v30, s70
    v_mov_b32 v31, s50
    s_mov_b64 exec, 0xff
    buffer_store_dwordx4 v[28:31], v4, s[52:55], s66 offen sc0 sc1
    s_mov_b64 exec, -1
    s_branch L_voted
L_novote:
    s_waitcnt vmcnt(0)
    v_readfirstlane_b32 s50, v31
    s_nop 0
    s_and_b32 s50, s50, -4
    s_mul_i32 s50, s50, 0x2c9277b5
    s_add_u32 s50, s50, 0x3c6ef35c
    s_sleep 24
L_voted:
    v_mov_b32 v14, 0
    v_mov_b32 v13, 1
    ds_write_b32 v14, v13 offset:56
    s_mov_b32 s49, 262144
    s_mov_b32 s48, 278528
    s_mov_b32 s89, 100000
    s_sleep 36
    s_branch L_pv01
L_pv0:
L_pv01:
    buffer_load_dwordx4 v[16:19], v27, s[52:55], s49 offen sc0 sc1
    s_sub_u32 s89, s89, 1
    s_waitcnt vmcnt(0)
    v_xor_b32 v12, s50, v17
    v_xor_b32 v13, s50, v19
    v_or_b32 v12, v12, v13
    v_cmp_ne_u32 vcc, 0, v12
    s_cmp_eq_u32 s89, 0
    s_cbranch_scc1 L_pv0go
    s_mov_b64 exec, vcc
    s_cbranch_vccnz L_pv0
L_pv0go:
    s_mov_b64 exec, -1
    v_readlane_b32 s81, v16, 0
    v_ashrrev_i32 v16, 1, v16
    v_bfe_i32 v17, v18, 0, 16
    v_ashrrev_i32 v18, 16, v18
    v_mov_b32 v19, 0
    v_permlane16_swap_b32 v16, v17
    s_nop 0
    v_permlane16_swap_b32 v18, v19
    v_add_u32 v16, v16, v17
    v_add_u32 v18, v18, v19
    s_nop 1
    v_permlane32_swap_b32 v16, v18
    v_add_u32 v16, v16, v18
    s_nop 1
    v_add_u32_dpp v16, v16, v16 row_ror:1 row_mask:0xf bank_mask:0xf
    s_nop 1
    v_add_u32_dpp v16, v16, v16 row_ror:2 row_mask:0xf bank_mask:0xf
    s_nop 1
    v_add_u32_dpp v16, v16, v16 row_ror:4 row_mask:0xf bank_mask:0xf
    s_nop 1
    v_add_u32_dpp v16, v16, v16 row_ror:8 row_mask:0xf bank_mask:0xf
    s_nop 0
    v_readlane_b32 s86, v16, 0
    v_readlane_b32 s87, v16, 16
    v_readlane_b32 s88, v16, 32
    s_cmp_gt_i32 s86, 0
    s_cselect_b32 s87, s87, s88
    s_cselect_b32 s88, 1, 0
    s_xor_b32 s88, s88, s81
    s_and_b32 s88, s88, 1
    s_lshr_b32 s85, s87, 31
    s_lshl_b32 s85, s85, 1
    s_or_b32 s88, s88, s85
    s_lshl_b32 s88, s88, 1
    s_xor_b32 s88, s88, 8
    v_mov_b32 v13, s88
    ds_write_b32 v14, v13 offset:16
    s_mov_b32 s49, 270336
    s_mov_b32 s48, 286720
    s_mov_b32 s89, 100000
    s_sleep 32
    s_branch L_pv11
L_pv1:
    s_sleep 16
L_pv11:
    buffer_load_dwordx4 v[16:19], v27, s[52:55], s49 offen sc0 sc1
    s_sub_u32 s89, s89, 1
    s_waitcnt vmcnt(0)
    v_xor_b32 v12, s50, v17
    v_xor_b32 v13, s50, v19
    v_or_b32 v12, v12, v13
    v_cmp_ne_u32 vcc, 0, v12
    s_cmp_eq_u32 s89, 0
    s_cbranch_scc1 L_pv1go
    s_mov_b64 exec, vcc
    s_cbranch_vccnz L_pv1
L_pv1go:
    s_mov_b64 exec, -1
    v_ashrrev_i32 v16, 1, v16
    v_bfe_i32 v17, v18, 0, 16
    v_ashrrev_i32 v18, 16, v18
    v_mov_b32 v19, 0
    v_permlane16_swap_b32 v16, v17
    s_nop 0
    v_permlane16_swap_b32 v18, v19
    v_add_u32 v16, v16, v17
    v_add_u32 v18, v18, v19
    s_nop 1
    v_permlane32_swap_b32 v16, v18
    v_add_u32 v16, v16, v18
    s_nop 1
    v_add_u32_dpp v16, v16, v16 row_ror:1 row_mask:0xf bank_mask:0xf
    s_nop 1
    v_add_u32_dpp v16, v16, v16 row_ror:2 row_mask:0xf bank_mask:0xf
    s_nop 1
    v_add_u32_dpp v16, v16, v16 row_ror:4 row_mask:0xf bank_mask:0xf
    s_nop 1
    v_add_u32_dpp v16, v16, v16 row_ror:8 row_mask:0xf bank_mask:0xf
    s_nop 0
    v_readlane_b32 s86, v16, 0
    v_readlane_b32 s87, v16, 16
    v_readlane_b32 s88, v16, 32
    s_cmp_gt_i32 s86, 0
    s_cselect_b32 s87, s87, s88
    s_cselect_b32 s88, 1, 0
    s_xor_b32 s88, s88, s81
    s_and_b32 s88, s88, 1
    s_lshr_b32 s85, s87, 31
    s_lshl_b32 s85, s85, 1
    s_or_b32 s88, s88, s85
    s_lshl_b32 s88, s88, 1
    s_xor_b32 s88, s88, 8
    v_mov_b32 v13, s88
    ds_write_b32 v14, v13 offset:48
    s_endpgm
L_qwave:
    s_setprio 3
    v_lshrrev_b32 v6, 4, v1
    v_lshrrev_b32 v2, 3, v1
    v_and_b32 v3, 7, v1
    v_lshlrev_b32 v3, 4, v3
    v_lshl_add_u32 v7, v2, 13, v3
    v_lshlrev_b32 v3, 2, v3
    v_lshl_add_u32 v3, v6, 4, v3
    s_lshl_b32 s80, s4, 10
    s_lshl_b32 s81, s5, 7
    s_add_u32 s80, s80, s81
    s_mul_i32 s81, s6, 917504
    s_add_u32 s80, s80, s81
    s_lshl_b32 s85, s4, 14
    s_add_u32 s85, s85, 131072
    s_lshl_b32 s84, s7, 9
    s_add_u32 s84, s84, s85
    s_waitcnt lgkmcnt(0)
    s_mov_b32 s56, s16
    s_mov_b32 s57, s17
    s_mov_b32 s58, 896
    s_mov_b32 s59, 0x00020000
    s_mov_b32 s60, s22
    s_mov_b32 s61, s23
    s_mov_b32 s62, 3670016
    s_mov_b32 s63, 0x00020000
    s_mov_b32 s52, s40
    s_mov_b32 s53, s41
    s_mov_b32 s54, 16777216
    s_mov_b32 s55, 0x00020000
    buffer_load_dwordx4 v[12:15], v4, s[56:59], 0 offen
    buffer_load_dword v31, off, s[52:55], s51 sc0 sc1
    s_add_u32 s81, s80, 0
    buffer_load_dwordx4 v[32:35], v7, s[60:63], s81 offen nt
    s_add_u32 s81, s80, 65536
    buffer_load_dwordx4 v[36:39], v7, s[60:63], s81 offen nt
    s_add_u32 s81, s80, 131072
    buffer_load_dwordx4 v[40:43], v7, s[60:63], s81 offen nt
    s_add_u32 s81, s80, 196608
    buffer_load_dwordx4 v[44:47], v7, s[60:63], s81 offen nt
    s_add_u32 s81, s80, 262144
    buffer_load_dwordx4 v[48:51], v7, s[60:63], s81 offen nt
    s_add_u32 s81, s80, 327680
    buffer_load_dwordx4 v[52:55], v7, s[60:63], s81 offen nt
    s_add_u32 s81, s80, 393216
    buffer_load_dwordx4 v[56:59], v7, s[60:63], s81 offen nt
    s_add_u32 s81, s80, 458752
    buffer_load_dwordx4 v[60:63], v7, s[60:63], s81 offen nt
    s_add_u32 s81, s80, 524288
    buffer_load_dwordx4 v[64:67], v7, s[60:63], s81 offen nt
    s_add_u32 s81, s80, 589824
    buffer_load_dwordx4 v[68:71], v7, s[60:63], s81 offen nt
    s_add_u32 s81, s80, 655360
    buffer_load_dwordx4 v[72:75], v7, s[60:63], s81 offen nt
    s_add_u32 s81, s80, 720896
    buffer_load_dwordx4 v[76:79], v7, s[60:63], s81 offen nt
    s_add_u32 s81, s80, 786432
    buffer_load_dwordx4 v[80:83], v7, s[60:63], s81 offen nt
    s_add_u32 s81, s80, 851968
    buffer_load_dwordx4 v[84:87], v7, s[60:63], s81 offen nt
    v_mov_b32 v8, 0
    v_mov_b32 v9, 1
    ds_write_b32 v8, v9 offset:52
    s_waitcnt vmcnt(15)
    v_lshlrev_b32 v16, 16, v12
    v_and_b32 v17, 0xffff0000, v12
    v_lshlrev_b32 v18, 16, v13
    v_and_b32 v19, 0xffff0000, v13
    v_lshlrev_b32 v20, 16, v14
    v_and_b32 v21, 0xffff0000, v14
    v_lshlrev_b32 v22, 16, v15
    v_and_b32 v23, 0xffff0000, v15
    v_add_f32 v12, v16, v17
    v_add_f32 v13, v18, v19
    v_add_f32 v14, v20, v21
    v_add_f32 v15, v22, v23
    v_add_f32 v12, v12, v13
    v_add_f32 v14, v14, v15
    v_add_f32 v12, v12, v14
    s_nop 1
    v_add_f32_dpp v12, v12, v12 row_ror:1 row_mask:0xf bank_mask:0xf
    s_nop 1
    v_add_f32_dpp v12, v12, v12 row_ror:2 row_mask:0xf bank_mask:0xf
    s_nop 1
    v_add_f32_dpp v12, v12, v12 row_ror:4 row_mask:0xf bank_mask:0xf
    s_nop 1
    v_add_f32_dpp v12, v12, v12 row_ror:8 row_mask:0xf bank_mask:0xf
    v_mov_b32 v13, v12
    s_nop 1
    v_permlane16_swap_b32 v12, v13
    v_add_f32 v12, v12, v13
    v_mov_b32 v13, v12
    s_nop 1
    v_permlane32_swap_b32 v12, v13
    v_add_f32 v12, v12, v13
    v_mul_f32 v12, 0x3b124925, v12
    v_mov_b32 v14, 0
    s_mov_b32 exec_hi, 0x00ffffff
    v_sub_f32 v24, v16, v12
    v_fmac_f32 v14, v24, v24
    v_sub_f32 v25, v17, v12
    v_fmac_f32 v14, v25, v25
    v_sub_f32 v24, v18, v12
    v_fmac_f32 v14, v24, v24
    v_sub_f32 v25, v19, v12
    v_fmac_f32 v14, v25, v25
    v_sub_f32 v24, v20, v12
    v_fmac_f32 v14, v24, v24
    v_sub_f32 v25, v21, v12
    v_fmac_f32 v14, v25, v25
    v_sub_f32 v24, v22, v12
    v_fmac_f32 v14, v24, v24
    v_sub_f32 v25, v23, v12
    v_fmac_f32 v14, v25, v25
    s_mov_b32 exec_hi, -1
    s_nop 0
    v_add_f32_dpp v14, v14, v14 row_ror:1 row_mask:0xf bank_mask:0xf
    s_nop 1
    v_add_f32_dpp v14, v14, v14 row_ror:2 row_mask:0xf bank_mask:0xf
    s_nop 1
    v_add_f32_dpp v14, v14, v14 row_ror:4 row_mask:0xf bank_mask:0xf
    s_nop 1
    v_add_f32_dpp v14, v14, v14 row_ror:8 row_mask:0xf bank_mask:0xf
    v_mov_b32 v13, v14
    s_nop 1
    v_permlane16_swap_b32 v14, v13
    v_add_f32 v14, v14, v13
    v_mov_b32 v13, v14
    s_nop 1
    v_permlane32_swap_b32 v14, v13
    v_add_f32 v14, v14, v13
    v_mul_f32 v14, 0x3b124925, v14
    v_cvt_pk_bf16_f32 v12, v12, v12
    v_and_b32 v12, 0xffff0000, v12
    v_cvt_pk_bf16_f32 v14, v14, v14
    v_and_b32 v14, 0xffff0000, v14
    v_add_f32 v14, 0x3727c5ac, v14
    v_cvt_pk_bf16_f32 v14, v14, v14
    v_and_b32 v14, 0xffff0000, v14
    v_sqrt_f32 v14, v14
    s_nop 0
    v_cvt_pk_bf16_f32 v14, v14, v14
    v_and_b32 v14, 0xffff0000, v14
    v_rcp_f32 v15, v14
    v_sub_f32 v16, v16, v12
    v_sub_f32 v17, v17, v12
    v_sub_f32 v18, v18, v12
    v_sub_f32 v19, v19, v12
    v_sub_f32 v20, v20, v12
    v_sub_f32 v21, v21, v12
    v_sub_f32 v22, v22, v12
    v_sub_f32 v23, v23, v12
    v_cvt_pk_bf16_f32 v16, v16, v16
    v_and_b32 v16, 0xffff0000, v16
    v_cvt_pk_bf16_f32 v17, v17, v17
    v_and_b32 v17, 0xffff0000, v17
    v_cvt_pk_bf16_f32 v18, v18, v18
    v_and_b32 v18, 0xffff0000, v18
    v_cvt_pk_bf16_f32 v19, v19, v19
    v_and_b32 v19, 0xffff0000, v19
    v_cvt_pk_bf16_f32 v20, v20, v20
    v_and_b32 v20, 0xffff0000, v20
    v_cvt_pk_bf16_f32 v21, v21, v21
    v_and_b32 v21, 0xffff0000, v21
    v_cvt_pk_bf16_f32 v22, v22, v22
    v_and_b32 v22, 0xffff0000, v22
    v_cvt_pk_bf16_f32 v23, v23, v23
    v_and_b32 v23, 0xffff0000, v23
    v_mul_f32 v24, v16, v15
    v_fma_f32 v16, -v24, v14, v16
    v_fma_f32 v16, v16, v15, v24
    v_mul_f32 v25, v17, v15
    v_fma_f32 v17, -v25, v14, v17
    v_fma_f32 v17, v17, v15, v25
    v_mul_f32 v26, v18, v15
    v_fma_f32 v18, -v26, v14, v18
    v_fma_f32 v18, v18, v15, v26
    v_mul_f32 v27, v19, v15
    v_fma_f32 v19, -v27, v14, v19
    v_fma_f32 v19, v19, v15, v27
    v_mul_f32 v24, v20, v15
    v_fma_f32 v20, -v24, v14, v20
    v_fma_f32 v20, v20, v15, v24
    v_mul_f32 v25, v21, v15
    v_fma_f32 v21, -v25, v14, v21
    v_fma_f32 v21, v21, v15, v25
    v_mul_f32 v26, v22, v15
    v_fma_f32 v22, -v26, v14, v22
    v_fma_f32 v22, v22, v15, v26
    v_mul_f32 v27, v23, v15
    v_fma_f32 v23, -v27, v14, v23
    v_fma_f32 v23, v23, v15, v27
    v_cvt_pk_bf16_f32 v16, v16, v16
    v_and_b32 v16, 0xffff0000, v16
    v_cvt_pk_bf16_f32 v17, v17, v17
    v_and_b32 v17, 0xffff0000, v17
    v_cvt_pk_bf16_f32 v18, v18, v18
    v_and_b32 v18, 0xffff0000, v18
    v_cvt_pk_bf16_f32 v19, v19, v19
    v_and_b32 v19, 0xffff0000, v19
    v_cvt_pk_bf16_f32 v20, v20, v20
    v_and_b32 v20, 0xffff0000, v20
    v_cvt_pk_bf16_f32 v21, v21, v21
    v_and_b32 v21, 0xffff0000, v21
    v_cvt_pk_bf16_f32 v22, v22, v22
    v_and_b32 v22, 0xffff0000, v22
    v_cvt_pk_bf16_f32 v23, v23, v23
    v_and_b32 v23, 0xffff0000, v23
    v_lshlrev_b32 v12, 5, v1
    ds_write_b128 v12, v[16:19] offset:12544
    ds_write_b128 v12, v[20:23] offset:12560
    s_mul_i32 s81, s6, 448
    s_add_u32 s81, s81, 12544
    v_lshl_add_u32 v13, v2, 2, s81
    s_waitcnt lgkmcnt(0)
    ds_read2_b32 v[16:17], v13 offset0:0 offset1:8
    ds_read2_b32 v[18:19], v13 offset0:16 offset1:24
    ds_read2_b32 v[20:21], v13 offset0:32 offset1:40
    ds_read2_b32 v[22:23], v13 offset0:48 offset1:56
    ds_read2_b32 v[24:25], v13 offset0:64 offset1:72
    ds_read2_b32 v[26:27], v13 offset0:80 offset1:88
    ds_read2_b32 v[28:29], v13 offset0:96 offset1:104
    s_waitcnt lgkmcnt(0)
    s_waitcnt vmcnt(13)
    v_lshlrev_b32 v30, 16, v32
    v_and_b32 v32, 0xffff0000, v32
    v_mul_f32 v8, v30, v16
    v_mul_f32 v9, v32, v16
    v_lshlrev_b32 v30, 16, v33
    v_and_b32 v33, 0xffff0000, v33
    v_mul_f32 v10, v30, v16
    v_mul_f32 v11, v33, v16
    v_lshlrev_b32 v30, 16, v34
    v_and_b32 v34, 0xffff0000, v34
    v_mul_f32 v12, v30, v16
    v_mul_f32 v13, v34, v16
    v_lshlrev_b32 v30, 16, v35
    v_and_b32 v35, 0xffff0000, v35
    v_mul_f32 v14, v30, v16
    v_mul_f32 v15, v35, v16
    s_waitcnt vmcnt(12)
    v_lshlrev_b32 v30, 16, v36
    v_and_b32 v36, 0xffff0000, v36
    v_fmac_f32 v8, v30, v17
    v_fmac_f32 v9, v36, v17
    v_lshlrev_b32 v30, 16, v37
    v_and_b32 v37, 0xffff0000, v37
    v_fmac_f32 v10, v30, v17
    v_fmac_f32 v11, v37, v17
    v_lshlrev_b32 v30, 16, v38
    v_and_b32 v38, 0xffff0000, v38
    v_fmac_f32 v12, v30, v17
    v_fmac_f32 v13, v38, v17
    v_lshlrev_b32 v30, 16, v39
    v_and_b32 v39, 0xffff0000, v39
    v_fmac_f32 v14, v30, v17
    v_fmac_f32 v15, v39, v17
    s_waitcnt vmcnt(11)
    v_lshlrev_b32 v30, 16, v40
    v_and_b32 v40, 0xffff0000, v40
    v_fmac_f32 v8, v30, v18
    v_fmac_f32 v9, v40, v18
    v_lshlrev_b32 v30, 16, v41
    v_and_b32 v41, 0xffff0000, v41
    v_fmac_f32 v10, v30, v18
    v_fmac_f32 v11, v41, v18
    v_lshlrev_b32 v30, 16, v42
    v_and_b32 v42, 0xffff0000, v42
    v_fmac_f32 v12, v30, v18
    v_fmac_f32 v13, v42, v18
    v_lshlrev_b32 v30, 16, v43
    v_and_b32 v43, 0xffff0000, v43
    v_fmac_f32 v14, v30, v18
    v_fmac_f32 v15, v43, v18
    s_waitcnt vmcnt(10)
    v_lshlrev_b32 v30, 16, v44
    v_and_b32 v44, 0xffff0000, v44
    v_fmac_f32 v8, v30, v19
    v_fmac_f32 v9, v44, v19
    v_lshlrev_b32 v30, 16, v45
    v_and_b32 v45, 0xffff0000, v45
    v_fmac_f32 v10, v30, v19
    v_fmac_f32 v11, v45, v19
    v_lshlrev_b32 v30, 16, v46
    v_and_b32 v46, 0xffff0000, v46
    v_fmac_f32 v12, v30, v19
    v_fmac_f32 v13, v46, v19
    v_lshlrev_b32 v30, 16, v47
    v_and_b32 v47, 0xffff0000, v47
    v_fmac_f32 v14, v30, v19
    v_fmac_f32 v15, v47, v19
    s_waitcnt vmcnt(9)
    v_lshlrev_b32 v30, 16, v48
    v_and_b32 v48, 0xffff0000, v48
    v_fmac_f32 v8, v30, v20
    v_fmac_f32 v9, v48, v20
    v_lshlrev_b32 v30, 16, v49
    v_and_b32 v49, 0xffff0000, v49
    v_fmac_f32 v10, v30, v20
    v_fmac_f32 v11, v49, v20
    v_lshlrev_b32 v30, 16, v50
    v_and_b32 v50, 0xffff0000, v50
    v_fmac_f32 v12, v30, v20
    v_fmac_f32 v13, v50, v20
    v_lshlrev_b32 v30, 16, v51
    v_and_b32 v51, 0xffff0000, v51
    v_fmac_f32 v14, v30, v20
    v_fmac_f32 v15, v51, v20
    s_waitcnt vmcnt(8)
    v_lshlrev_b32 v30, 16, v52
    v_and_b32 v52, 0xffff0000, v52
    v_fmac_f32 v8, v30, v21
    v_fmac_f32 v9, v52, v21
    v_lshlrev_b32 v30, 16, v53
    v_and_b32 v53, 0xffff0000, v53
    v_fmac_f32 v10, v30, v21
    v_fmac_f32 v11, v53, v21
    v_lshlrev_b32 v30, 16, v54
    v_and_b32 v54, 0xffff0000, v54
    v_fmac_f32 v12, v30, v21
    v_fmac_f32 v13, v54, v21
    v_lshlrev_b32 v30, 16, v55
    v_and_b32 v55, 0xffff0000, v55
    v_fmac_f32 v14, v30, v21
    v_fmac_f32 v15, v55, v21
    s_waitcnt vmcnt(7)
    v_lshlrev_b32 v30, 16, v56
    v_and_b32 v56, 0xffff0000, v56
    v_fmac_f32 v8, v30, v22
    v_fmac_f32 v9, v56, v22
    v_lshlrev_b32 v30, 16, v57
    v_and_b32 v57, 0xffff0000, v57
    v_fmac_f32 v10, v30, v22
    v_fmac_f32 v11, v57, v22
    v_lshlrev_b32 v30, 16, v58
    v_and_b32 v58, 0xffff0000, v58
    v_fmac_f32 v12, v30, v22
    v_fmac_f32 v13, v58, v22
    v_lshlrev_b32 v30, 16, v59
    v_and_b32 v59, 0xffff0000, v59
    v_fmac_f32 v14, v30, v22
    v_fmac_f32 v15, v59, v22
    s_waitcnt vmcnt(6)
    v_lshlrev_b32 v30, 16, v60
    v_and_b32 v60, 0xffff0000, v60
    v_fmac_f32 v8, v30, v23
    v_fmac_f32 v9, v60, v23
    v_lshlrev_b32 v30, 16, v61
    v_and_b32 v61, 0xffff0000, v61
    v_fmac_f32 v10, v30, v23
    v_fmac_f32 v11, v61, v23
    v_lshlrev_b32 v30, 16, v62
    v_and_b32 v62, 0xffff0000, v62
    v_fmac_f32 v12, v30, v23
    v_fmac_f32 v13, v62, v23
    v_lshlrev_b32 v30, 16, v63
    v_and_b32 v63, 0xffff0000, v63
    v_fmac_f32 v14, v30, v23
    v_fmac_f32 v15, v63, v23
    s_waitcnt vmcnt(5)
    v_lshlrev_b32 v30, 16, v64
    v_and_b32 v64, 0xffff0000, v64
    v_fmac_f32 v8, v30, v24
    v_fmac_f32 v9, v64, v24
    v_lshlrev_b32 v30, 16, v65
    v_and_b32 v65, 0xffff0000, v65
    v_fmac_f32 v10, v30, v24
    v_fmac_f32 v11, v65, v24
    v_lshlrev_b32 v30, 16, v66
    v_and_b32 v66, 0xffff0000, v66
    v_fmac_f32 v12, v30, v24
    v_fmac_f32 v13, v66, v24
    v_lshlrev_b32 v30, 16, v67
    v_and_b32 v67, 0xffff0000, v67
    v_fmac_f32 v14, v30, v24
    v_fmac_f32 v15, v67, v24
    s_waitcnt vmcnt(4)
    v_lshlrev_b32 v30, 16, v68
    v_and_b32 v68, 0xffff0000, v68
    v_fmac_f32 v8, v30, v25
    v_fmac_f32 v9, v68, v25
    v_lshlrev_b32 v30, 16, v69
    v_and_b32 v69, 0xffff0000, v69
    v_fmac_f32 v10, v30, v25
    v_fmac_f32 v11, v69, v25
    v_lshlrev_b32 v30, 16, v70
    v_and_b32 v70, 0xffff0000, v70
    v_fmac_f32 v12, v30, v25
    v_fmac_f32 v13, v70, v25
    v_lshlrev_b32 v30, 16, v71
    v_and_b32 v71, 0xffff0000, v71
    v_fmac_f32 v14, v30, v25
    v_fmac_f32 v15, v71, v25
    s_waitcnt vmcnt(3)
    v_lshlrev_b32 v30, 16, v72
    v_and_b32 v72, 0xffff0000, v72
    v_fmac_f32 v8, v30, v26
    v_fmac_f32 v9, v72, v26
    v_lshlrev_b32 v30, 16, v73
    v_and_b32 v73, 0xffff0000, v73
    v_fmac_f32 v10, v30, v26
    v_fmac_f32 v11, v73, v26
    v_lshlrev_b32 v30, 16, v74
    v_and_b32 v74, 0xffff0000, v74
    v_fmac_f32 v12, v30, v26
    v_fmac_f32 v13, v74, v26
    v_lshlrev_b32 v30, 16, v75
    v_and_b32 v75, 0xffff0000, v75
    v_fmac_f32 v14, v30, v26
    v_fmac_f32 v15, v75, v26
    s_waitcnt vmcnt(2)
    v_lshlrev_b32 v30, 16, v76
    v_and_b32 v76, 0xffff0000, v76
    v_fmac_f32 v8, v30, v27
    v_fmac_f32 v9, v76, v27
    v_lshlrev_b32 v30, 16, v77
    v_and_b32 v77, 0xffff0000, v77
    v_fmac_f32 v10, v30, v27
    v_fmac_f32 v11, v77, v27
    v_lshlrev_b32 v30, 16, v78
    v_and_b32 v78, 0xffff0000, v78
    v_fmac_f32 v12, v30, v27
    v_fmac_f32 v13, v78, v27
    v_lshlrev_b32 v30, 16, v79
    v_and_b32 v79, 0xffff0000, v79
    v_fmac_f32 v14, v30, v27
    v_fmac_f32 v15, v79, v27
    s_waitcnt vmcnt(1)
    v_lshlrev_b32 v30, 16, v80
    v_and_b32 v80, 0xffff0000, v80
    v_fmac_f32 v8, v30, v28
    v_fmac_f32 v9, v80, v28
    v_lshlrev_b32 v30, 16, v81
    v_and_b32 v81, 0xffff0000, v81
    v_fmac_f32 v10, v30, v28
    v_fmac_f32 v11, v81, v28
    v_lshlrev_b32 v30, 16, v82
    v_and_b32 v82, 0xffff0000, v82
    v_fmac_f32 v12, v30, v28
    v_fmac_f32 v13, v82, v28
    v_lshlrev_b32 v30, 16, v83
    v_and_b32 v83, 0xffff0000, v83
    v_fmac_f32 v14, v30, v28
    v_fmac_f32 v15, v83, v28
    s_waitcnt vmcnt(0)
    v_lshlrev_b32 v30, 16, v84
    v_and_b32 v84, 0xffff0000, v84
    v_fmac_f32 v8, v30, v29
    v_fmac_f32 v9, v84, v29
    v_lshlrev_b32 v30, 16, v85
    v_and_b32 v85, 0xffff0000, v85
    v_fmac_f32 v10, v30, v29
    v_fmac_f32 v11, v85, v29
    v_lshlrev_b32 v30, 16, v86
    v_and_b32 v86, 0xffff0000, v86
    v_fmac_f32 v12, v30, v29
    v_fmac_f32 v13, v86, v29
    v_lshlrev_b32 v30, 16, v87
    v_and_b32 v87, 0xffff0000, v87
    v_fmac_f32 v14, v30, v29
    v_fmac_f32 v15, v87, v29
    v_permlane16_swap_b32 v8, v10
    v_permlane16_swap_b32 v12, v14
    v_permlane16_swap_b32 v9, v11
    v_permlane16_swap_b32 v13, v15
    v_add_f32 v8, v8, v10
    v_add_f32 v12, v12, v14
    v_add_f32 v9, v9, v11
    v_add_f32 v13, v13, v15
    v_permlane32_swap_b32 v8, v12
    s_nop 0
    v_permlane32_swap_b32 v9, v13
    v_add_f32 v8, v8, v12
    v_add_f32 v9, v9, v13
    s_nop 0
    v_add_f32_dpp v8, v8, v8 row_ror:8 row_mask:0xf bank_mask:0xf
    v_add_f32_dpp v9, v9, v9 row_ror:8 row_mask:0xf bank_mask:0xf
    v_readfirstlane_b32 s50, v31
    s_nop 0
    s_and_b32 s50, s50, -4
    s_mul_i32 s50, s50, 0x2c9277b5
    s_add_u32 s50, s50, 0x3c6ef35c
    v_mov_b32 v10, v9
    v_mov_b32 v9, s50
    v_mov_b32 v11, s50
    s_mov_b32 exec_lo, 0x00ff00ff
    s_mov_b32 exec_hi, 0x00ff00ff
    buffer_store_dwordx4 v[8:11], v3, s[52:55], s84 offen sc0 sc1
    s_mov_b64 exec, -1
    s_mov_b32 s89, 100000
    s_sleep 24
    s_branch L_pq1
L_pq:
L_pq1:
    s_add_u32 s81, s85, 0
    buffer_load_dwordx4 v[32:35], v4, s[52:55], s81 offen offset:0 sc0 sc1
    buffer_load_dwordx4 v[36:39], v4, s[52:55], s81 offen offset:1024 sc0 sc1
    buffer_load_dwordx4 v[40:43], v4, s[52:55], s81 offen offset:2048 sc0 sc1
    buffer_load_dwordx4 v[44:47], v4, s[52:55], s81 offen offset:3072 sc0 sc1
    s_add_u32 s81, s85, 4096
    buffer_load_dwordx4 v[48:51], v4, s[52:55], s81 offen offset:0 sc0 sc1
    buffer_load_dwordx4 v[52:55], v4, s[52:55], s81 offen offset:1024 sc0 sc1
    buffer_load_dwordx4 v[56:59], v4, s[52:55], s81 offen offset:2048 sc0 sc1
    buffer_load_dwordx4 v[60:63], v4, s[52:55], s81 offen offset:3072 sc0 sc1
    s_add_u32 s81, s85, 8192
    buffer_load_dwordx4 v[64:67], v4, s[52:55], s81 offen offset:0 sc0 sc1
    buffer_load_dwordx4 v[68:71], v4, s[52:55], s81 offen offset:1024 sc0 sc1
    buffer_load_dwordx4 v[72:75], v4, s[52:55], s81 offen offset:2048 sc0 sc1
    buffer_load_dwordx4 v[76:79], v4, s[52:55], s81 offen offset:3072 sc0 sc1
    s_add_u32 s81, s85, 12288
    buffer_load_dwordx4 v[80:83], v4, s[52:55], s81 offen offset:0 sc0 sc1
    buffer_load_dwordx4 v[84:87], v4, s[52:55], s81 offen offset:1024 sc0 sc1
    buffer_load_dwordx4 v[88:91], v4, s[52:55], s81 offen offset:2048 sc0 sc1
    buffer_load_dwordx4 v[92:95], v4, s[52:55], s81 offen offset:3072 sc0 sc1
    s_sub_u32 s89, s89, 1
    s_waitcnt vmcnt(0)
    v_min3_u32 v12, v33, v35, v37
    v_max3_u32 v13, v33, v35, v37
    v_min3_u32 v12, v12, v39, v41
    v_max3_u32 v13, v13, v39, v41
    v_min3_u32 v12, v12, v43, v45
    v_max3_u32 v13, v13, v43, v45
    v_min3_u32 v12, v12, v47, v49
    v_max3_u32 v13, v13, v47, v49
    v_min3_u32 v12, v12, v51, v53
    v_max3_u32 v13, v13, v51, v53
    v_min3_u32 v12, v12, v55, v57
    v_max3_u32 v13, v13, v55, v57
    v_min3_u32 v12, v12, v59, v61
    v_max3_u32 v13, v13, v59, v61
    v_min3_u32 v12, v12, v63, v65
    v_max3_u32 v13, v13, v63, v65
    v_min3_u32 v12, v12, v67, v69
    v_max3_u32 v13, v13, v67, v69
    v_min3_u32 v12, v12, v71, v73
    v_max3_u32 v13, v13, v71, v73
    v_min3_u32 v12, v12, v75, v77
    v_max3_u32 v13, v13, v75, v77
    v_min3_u32 v12, v12, v79, v81
    v_max3_u32 v13, v13, v79, v81
    v_min3_u32 v12, v12, v83, v85
    v_max3_u32 v13, v13, v83, v85
    v_min3_u32 v12, v12, v87, v89
    v_max3_u32 v13, v13, v87, v89
    v_min3_u32 v12, v12, v91, v93
    v_max3_u32 v13, v13, v91, v93
    v_min_u32 v12, v12, v95
    v_max_u32 v13, v13, v95
    v_xor_b32 v12, s50, v12
    v_xor_b32 v13, s50, v13
    v_or_b32 v12, v12, v13
    v_cmp_ne_u32 vcc, 0, v12
    s_cmp_eq_u32 s89, 0
    s_cbranch_scc1 L_pqgo
    s_mov_b64 exec, vcc
    s_cbranch_vccnz L_pq
L_pqgo:
    s_mov_b64 exec, -1
    v_add_f32 v32, v32, v48
    v_add_f32 v64, v64, v80
    v_add_f32 v34, v34, v50
    v_add_f32 v66, v66, v82
    v_add_f32 v32, v32, v64
    v_add_f32 v34, v34, v66
    v_cvt_pk_bf16_f32 v16, v32, v34
    v_add_f32 v36, v36, v52
    v_add_f32 v68, v68, v84
    v_add_f32 v38, v38, v54
    v_add_f32 v70, v70, v86
    v_add_f32 v36, v36, v68
    v_add_f32 v38, v38, v70
    v_cvt_pk_bf16_f32 v17, v36, v38
    v_add_f32 v40, v40, v56
    v_add_f32 v72, v72, v88
    v_add_f32 v42, v42, v58
    v_add_f32 v74, v74, v90
    v_add_f32 v40, v40, v72
    v_add_f32 v42, v42, v74
    v_cvt_pk_bf16_f32 v18, v40, v42
    v_add_f32 v44, v44, v60
    v_add_f32 v76, v76, v92
    v_add_f32 v46, v46, v62
    v_add_f32 v78, v78, v94
    v_add_f32 v44, v44, v76
    v_add_f32 v46, v46, v78
    v_cvt_pk_bf16_f32 v19, v44, v46
    v_lshlrev_b32 v12, 2, v1
    v_add_u32 v12, 256, v12
    ds_write2_b32 v12, v16, v17 offset0:0 offset1:64
    ds_write2_b32 v12, v18, v19 offset0:128 offset1:192
    v_mov_b32 v13, 1
    v_mov_b32 v14, 0
    s_waitcnt lgkmcnt(0)
    ds_write_b32 v14, v13 offset:24
    s_endpgm
L_stream:
    s_cmp_lg_u32 s3, 0
    s_cbranch_scc1 L_nocpf
    s_getpc_b64 s[44:45]
L_pc:
    s_sub_u32 s44, s44, L_pc-parallel_sum__gqa_block_cached__dense_activation_gelu__decode_kernel
    s_subb_u32 s45, s45, 0
    s_mov_b32 s46, L_codeend-parallel_sum__gqa_block_cached__dense_activation_gelu__decode_kernel
    s_mov_b32 s47, 0x00020000
    v_lshlrev_b32 v8, 9, v1
    s_lshl_b32 s48, s6, 7
    s_mov_b32 exec_hi, 0
    buffer_load_dword v9, v8, s[44:47], s48 offen
    s_mov_b32 exec_hi, -1
L_nocpf:
    v_and_b32 v2, 3, v1
    v_lshlrev_b32 v2, 4, v2
    v_lshrrev_b32 v6, 4, v1
    v_lshl_add_u32 v2, v6, 6, v2
    v_bfe_u32 v7, v1, 2, 2
    v_lshl_add_u32 v2, v7, 9, v2
    v_and_b32 v3, 15, v1
    v_lshlrev_b32 v3, 4, v3
    v_lshl_add_u32 v3, v6, 9, v3
    s_lshr_b32 s80, s5, 1
    s_and_b32 s81, s5, 1
    s_lshl_b32 s81, s81, 2
    s_or_b32 s80, s80, s81
    s_bfe_u32 s81, s4, 0x10001
    s_lshl_b32 s81, s81, 2
    s_xor_b32 s80, s80, s81
    s_lshr_b32 s81, s4, 2
    s_xor_b32 s80, s80, s81
    s_and_b32 s81, s4, 1
    s_lshl_b32 s81, s81, 2
    s_xor_b32 s80, s80, s81
    s_lshr_b32 s81, s4, 1
    s_xor_b32 s80, s80, s81
    s_lshl_b32 s80, s80, 12
    s_lshl_b32 s81, s6, 2
    s_add_u32 s81, s81, s3
    s_lshl_b32 s81, s81, 15
    s_or_b32 s80, s80, s81
    s_lshl_b32 s81, s4, 19
    s_or_b32 s80, s80, s81
    v_and_b32 v6, 7, v1
    v_lshrrev_b32 v7, 1, v6
    v_and_b32 v6, 1, v6
    v_cmp_eq_u32 vcc, 1, v6
    v_mov_b32 v72, 0x0c0c0100
    v_mov_b32 v73, 0x01000c0c
    v_cndmask_b32 v72, v72, v73, vcc
    v_mov_b32 v74, 0x0c0c0302
    v_mov_b32 v73, 0x03020c0c
    v_cndmask_b32 v74, v74, v73, vcc
    v_mov_b32 v73, 0x0c0c0c0c
    v_cmp_eq_u32 vcc, 0, v7
    s_nop 1
    v_cndmask_b32 v56, v73, v72, vcc
    v_cndmask_b32 v60, v73, v74, vcc
    v_cmp_eq_u32 vcc, 1, v7
    s_nop 1
    v_cndmask_b32 v57, v73, v72, vcc
    v_cndmask_b32 v61, v73, v74, vcc
    v_cmp_eq_u32 vcc, 2, v7
    s_nop 1
    v_cndmask_b32 v58, v73, v72, vcc
    v_cndmask_b32 v62, v73, v74, vcc
    v_cmp_eq_u32 vcc, 3, v7
    s_nop 1
    v_cndmask_b32 v59, v73, v72, vcc
    v_cndmask_b32 v63, v73, v74, vcc
    v_mov_b32 v64, 0
    v_mov_b32 v65, 0
    v_mov_b32 v66, 0
    v_mov_b32 v67, 0
    v_mov_b32 v68, 0
    v_mov_b32 v69, 0
    v_mov_b32 v70, 0
    v_mov_b32 v71, 0
    s_mov_b32 s90, 0xcccccccc
    s_mov_b32 s91, 0xcccccccc
    v_and_b32 v32, 1, v1
    v_lshlrev_b32 v32, 9, v32
    v_lshrrev_b32 v6, 2, v1
    v_lshl_add_u32 v32, v6, 4, v32
    s_lshl_b32 s86, s3, 10
    v_add_u32 v33, s86, v4
    v_mov_b32 v34, 1
    v_mov_b32 v35, 0
    s_lshl_b32 s81, s4, 25
    s_waitcnt lgkmcnt(0)
    s_add_u32 s44, s18, s81
    s_addc_u32 s45, s19, 0
    s_mov_b32 s46, 0x2000000
    s_mov_b32 s47, 0x00020000
    s_add_u32 s48, s20, s81
    s_addc_u32 s49, s21, 0
    s_mov_b32 s89, 400000
L_wk:
    ds_read_b32 v72, v35 offset:16
    s_sub_u32 s89, s89, 1
    s_waitcnt lgkmcnt(0)
    v_readfirstlane_b32 s83, v72
    s_cmp_eq_u32 s89, 0
    s_cbranch_scc1 L_wkgo
    s_cmp_lt_u32 s83, 1
    s_cbranch_scc1 L_wk
L_wkgo:
    s_and_b32 s83, s83, 7
    s_lshl_b32 s84, s83, 12
    s_xor_b32 s80, s80, s84
    s_xor_b32 s72, s80, 0
    buffer_load_dwordx4 v[96:99], v2, s[44:47], s72 offen offset:0 nt
    buffer_load_dwordx4 v[100:103], v2, s[44:47], s72 offen offset:256 nt
    buffer_load_dwordx4 v[104:107], v2, s[44:47], s72 offen offset:2048 nt
    buffer_load_dwordx4 v[108:111], v2, s[44:47], s72 offen offset:2304 nt
    s_xor_b32 s73, s80, 2105344
    buffer_load_dwordx4 v[112:115], v2, s[44:47], s73 offen offset:0 nt
    buffer_load_dwordx4 v[116:119], v2, s[44:47], s73 offen offset:256 nt
    buffer_load_dwordx4 v[120:123], v2, s[44:47], s73 offen offset:2048 nt
    buffer_load_dwordx4 v[124:127], v2, s[44:47], s73 offen offset:2304 nt
    s_xor_b32 s74, s80, 540672
    s_xor_b32 s75, s80, 2646016
    s_xor_b32 s76, s80, 1052672
    s_xor_b32 s77, s80, 3158016
    s_xor_b32 s78, s80, 1593344
    s_xor_b32 s79, s80, 3698688
    s_waitcnt vmcnt(5)
    buffer_load_dwordx4 v[128:131], v2, s[44:47], s74 offen offset:0 nt
    buffer_load_dwordx4 v[132:135], v2, s[44:47], s74 offen offset:256 nt
    buffer_load_dwordx4 v[136:139], v2, s[44:47], s74 offen offset:2048 nt
    buffer_load_dwordx4 v[140:143], v2, s[44:47], s74 offen offset:2304 nt
    s_mov_b32 s89, 400000
L_wq:
    ds_read_b32 v72, v35 offset:24
    s_sub_u32 s89, s89, 1
    s_waitcnt lgkmcnt(0)
    v_readfirstlane_b32 s84, v72
    s_cmp_eq_u32 s89, 0
    s_cbranch_scc1 L_wqgo
    s_cmp_lt_u32 s84, 1
    s_cbranch_scc1 L_wq
L_wqgo:
    ds_read_b128 v[8:11], v32 offset:256
    ds_read_b128 v[12:15], v32 offset:512
    s_waitcnt lgkmcnt(0)
    v_mov_b32 v7, 0
    s_mov_b32 s88, 0
L_kloop:
    s_waitcnt vmcnt(5)
    buffer_load_dwordx4 v[144:147], v2, s[44:47], s75 offen offset:0 nt
    buffer_load_dwordx4 v[148:151], v2, s[44:47], s75 offen offset:256 nt
    buffer_load_dwordx4 v[152:155], v2, s[44:47], s75 offen offset:2048 nt
    buffer_load_dwordx4 v[156:159], v2, s[44:47], s75 offen offset:2304 nt
    v_mfma_f32_16x16x32_bf16 v[16:19], v[96:99], v[8:11], 0
    v_mfma_f32_16x16x32_bf16 v[20:23], v[104:107], v[8:11], 0
    v_mfma_f32_16x16x32_bf16 v[16:19], v[100:103], v[12:15], v[16:19]
    v_mfma_f32_16x16x32_bf16 v[20:23], v[108:111], v[12:15], v[20:23]
    s_nop 6
    v_add_f32_dpp v73, v19, v18 row_ror:12 row_mask:0xf bank_mask:0xf
    v_add_f32_dpp v72, v17, v16 row_ror:12 row_mask:0xf bank_mask:0xf
    v_add_f32_dpp v75, v20, v23 row_ror:12 row_mask:0xf bank_mask:0xf
    v_add_f32_dpp v74, v22, v21 row_ror:12 row_mask:0xf bank_mask:0xf
    v_add_f32_dpp v24, v73, v72 row_ror:8 row_mask:0xf bank_mask:0x1
    s_nop 1
    v_add_f32_dpp v24, v75, v74 row_ror:8 row_mask:0xf bank_mask:0x2
    s_waitcnt vmcnt(5)
    buffer_load_dwordx4 v[96:99], v2, s[44:47], s76 offen offset:0 nt
    buffer_load_dwordx4 v[100:103], v2, s[44:47], s76 offen offset:256 nt
    buffer_load_dwordx4 v[104:107], v2, s[44:47], s76 offen offset:2048 nt
    buffer_load_dwordx4 v[108:111], v2, s[44:47], s76 offen offset:2304 nt
    v_mfma_f32_16x16x32_bf16 v[16:19], v[112:115], v[8:11], 0
    v_mfma_f32_16x16x32_bf16 v[20:23], v[120:123], v[8:11], 0
    v_mfma_f32_16x16x32_bf16 v[16:19], v[116:119], v[12:15], v[16:19]
    v_mfma_f32_16x16x32_bf16 v[20:23], v[124:127], v[12:15], v[20:23]
    s_nop 6
    v_add_f32_dpp v73, v17, v16 row_ror:12 row_mask:0xf bank_mask:0xf
    v_add_f32_dpp v72, v19, v18 row_ror:12 row_mask:0xf bank_mask:0xf
    v_add_f32_dpp v75, v22, v21 row_ror:12 row_mask:0xf bank_mask:0xf
    v_add_f32_dpp v74, v20, v23 row_ror:12 row_mask:0xf bank_mask:0xf
    v_add_f32_dpp v24, v73, v72 row_ror:8 row_mask:0xf bank_mask:0x4
    s_nop 1
    v_add_f32_dpp v24, v75, v74 row_ror:8 row_mask:0xf bank_mask:0x8
    s_waitcnt vmcnt(5)
    buffer_load_dwordx4 v[112:115], v2, s[44:47], s77 offen offset:0 nt
    buffer_load_dwordx4 v[116:119], v2, s[44:47], s77 offen offset:256 nt
    buffer_load_dwordx4 v[120:123], v2, s[44:47], s77 offen offset:2048 nt
    buffer_load_dwordx4 v[124:127], v2, s[44:47], s77 offen offset:2304 nt
    v_mfma_f32_16x16x32_bf16 v[16:19], v[128:131], v[8:11], 0
    v_mfma_f32_16x16x32_bf16 v[20:23], v[136:139], v[8:11], 0
    v_mfma_f32_16x16x32_bf16 v[16:19], v[132:135], v[12:15], v[16:19]
    v_mfma_f32_16x16x32_bf16 v[20:23], v[140:143], v[12:15], v[20:23]
    s_nop 6
    v_add_f32_dpp v73, v19, v18 row_ror:12 row_mask:0xf bank_mask:0xf
    v_add_f32_dpp v72, v17, v16 row_ror:12 row_mask:0xf bank_mask:0xf
    v_add_f32_dpp v75, v20, v23 row_ror:12 row_mask:0xf bank_mask:0xf
    v_add_f32_dpp v74, v22, v21 row_ror:12 row_mask:0xf bank_mask:0xf
    v_add_f32_dpp v25, v73, v72 row_ror:8 row_mask:0xf bank_mask:0x1
    s_nop 1
    v_add_f32_dpp v25, v75, v74 row_ror:8 row_mask:0xf bank_mask:0x2
    s_waitcnt vmcnt(5)
    buffer_load_dwordx4 v[128:131], v2, s[44:47], s78 offen offset:0 nt
    buffer_load_dwordx4 v[132:135], v2, s[44:47], s78 offen offset:256 nt
    buffer_load_dwordx4 v[136:139], v2, s[44:47], s78 offen offset:2048 nt
    buffer_load_dwordx4 v[140:143], v2, s[44:47], s78 offen offset:2304 nt
    v_mfma_f32_16x16x32_bf16 v[16:19], v[144:147], v[8:11], 0
    v_mfma_f32_16x16x32_bf16 v[20:23], v[152:155], v[8:11], 0
    v_mfma_f32_16x16x32_bf16 v[16:19], v[148:151], v[12:15], v[16:19]
    v_mfma_f32_16x16x32_bf16 v[20:23], v[156:159], v[12:15], v[20:23]
    s_nop 6
    v_add_f32_dpp v73, v17, v16 row_ror:12 row_mask:0xf bank_mask:0xf
    v_add_f32_dpp v72, v19, v18 row_ror:12 row_mask:0xf bank_mask:0xf
    v_add_f32_dpp v75, v22, v21 row_ror:12 row_mask:0xf bank_mask:0xf
    v_add_f32_dpp v74, v20, v23 row_ror:12 row_mask:0xf bank_mask:0xf
    v_add_f32_dpp v25, v73, v72 row_ror:8 row_mask:0xf bank_mask:0x4
    s_nop 1
    v_add_f32_dpp v25, v75, v74 row_ror:8 row_mask:0xf bank_mask:0x8
    v_cvt_pk_bf16_f32 v26, v24, v25
    s_waitcnt vmcnt(5)
    buffer_load_dwordx4 v[144:147], v2, s[44:47], s79 offen offset:0 nt
    buffer_load_dwordx4 v[148:151], v2, s[44:47], s79 offen offset:256 nt
    buffer_load_dwordx4 v[152:155], v2, s[44:47], s79 offen offset:2048 nt
    buffer_load_dwordx4 v[156:159], v2, s[44:47], s79 offen offset:2304 nt
    v_mfma_f32_16x16x32_bf16 v[16:19], v[96:99], v[8:11], 0
    v_mfma_f32_16x16x32_bf16 v[20:23], v[104:107], v[8:11], 0
    v_mfma_f32_16x16x32_bf16 v[16:19], v[100:103], v[12:15], v[16:19]
    v_mfma_f32_16x16x32_bf16 v[20:23], v[108:111], v[12:15], v[20:23]
    s_nop 6
    v_add_f32_dpp v73, v19, v18 row_ror:12 row_mask:0xf bank_mask:0xf
    v_add_f32_dpp v72, v17, v16 row_ror:12 row_mask:0xf bank_mask:0xf
    v_add_f32_dpp v75, v20, v23 row_ror:12 row_mask:0xf bank_mask:0xf
    v_add_f32_dpp v74, v22, v21 row_ror:12 row_mask:0xf bank_mask:0xf
    v_add_f32_dpp v24, v73, v72 row_ror:8 row_mask:0xf bank_mask:0x1
    s_nop 1
    v_add_f32_dpp v24, v75, v74 row_ror:8 row_mask:0xf bank_mask:0x2
    v_add_u32 v2, 0x400000, v2
    s_cmp_eq_u32 s88, 7
    s_cbranch_scc1 L_tov
L_tovback:
    s_waitcnt vmcnt(5)
    buffer_load_dwordx4 v[96:99], v2, s[44:47], s72 offen offset:0 nt
    buffer_load_dwordx4 v[100:103], v2, s[44:47], s72 offen offset:256 nt
    buffer_load_dwordx4 v[104:107], v2, s[44:47], s72 offen offset:2048 nt
    buffer_load_dwordx4 v[108:111], v2, s[44:47], s72 offen offset:2304 nt
    v_mfma_f32_16x16x32_bf16 v[16:19], v[112:115], v[8:11], 0
    v_mfma_f32_16x16x32_bf16 v[20:23], v[120:123], v[8:11], 0
    v_mfma_f32_16x16x32_bf16 v[16:19], v[116:119], v[12:15], v[16:19]
    v_mfma_f32_16x16x32_bf16 v[20:23], v[124:127], v[12:15], v[20:23]
    s_nop 6
    v_add_f32_dpp v73, v17, v16 row_ror:12 row_mask:0xf bank_mask:0xf
    v_add_f32_dpp v72, v19, v18 row_ror:12 row_mask:0xf bank_mask:0xf
    v_add_f32_dpp v75, v22, v21 row_ror:12 row_mask:0xf bank_mask:0xf
    v_add_f32_dpp v74, v20, v23 row_ror:12 row_mask:0xf bank_mask:0xf
    v_add_f32_dpp v24, v73, v72 row_ror:8 row_mask:0xf bank_mask:0x4
    s_nop 1
    v_add_f32_dpp v24, v75, v74 row_ror:8 row_mask:0xf bank_mask:0x8
    s_waitcnt vmcnt(5)
    buffer_load_dwordx4 v[112:115], v2, s[44:47], s73 offen offset:0 nt
    buffer_load_dwordx4 v[116:119], v2, s[44:47], s73 offen offset:256 nt
    buffer_load_dwordx4 v[120:123], v2, s[44:47], s73 offen offset:2048 nt
    buffer_load_dwordx4 v[124:127], v2, s[44:47], s73 offen offset:2304 nt
    v_mfma_f32_16x16x32_bf16 v[16:19], v[128:131], v[8:11], 0
    v_mfma_f32_16x16x32_bf16 v[20:23], v[136:139], v[8:11], 0
    v_mfma_f32_16x16x32_bf16 v[16:19], v[132:135], v[12:15], v[16:19]
    v_mfma_f32_16x16x32_bf16 v[20:23], v[140:143], v[12:15], v[20:23]
    s_nop 6
    v_add_f32_dpp v73, v19, v18 row_ror:12 row_mask:0xf bank_mask:0xf
    v_add_f32_dpp v72, v17, v16 row_ror:12 row_mask:0xf bank_mask:0xf
    v_add_f32_dpp v75, v20, v23 row_ror:12 row_mask:0xf bank_mask:0xf
    v_add_f32_dpp v74, v22, v21 row_ror:12 row_mask:0xf bank_mask:0xf
    v_add_f32_dpp v25, v73, v72 row_ror:8 row_mask:0xf bank_mask:0x1
    s_nop 1
    v_add_f32_dpp v25, v75, v74 row_ror:8 row_mask:0xf bank_mask:0x2
    s_waitcnt vmcnt(5)
    buffer_load_dwordx4 v[128:131], v2, s[44:47], s74 offen offset:0 nt
    buffer_load_dwordx4 v[132:135], v2, s[44:47], s74 offen offset:256 nt
    buffer_load_dwordx4 v[136:139], v2, s[44:47], s74 offen offset:2048 nt
    buffer_load_dwordx4 v[140:143], v2, s[44:47], s74 offen offset:2304 nt
    v_mfma_f32_16x16x32_bf16 v[16:19], v[144:147], v[8:11], 0
    v_mfma_f32_16x16x32_bf16 v[20:23], v[152:155], v[8:11], 0
    v_mfma_f32_16x16x32_bf16 v[16:19], v[148:151], v[12:15], v[16:19]
    v_mfma_f32_16x16x32_bf16 v[20:23], v[156:159], v[12:15], v[20:23]
    s_nop 6
    v_add_f32_dpp v73, v17, v16 row_ror:12 row_mask:0xf bank_mask:0xf
    v_add_f32_dpp v72, v19, v18 row_ror:12 row_mask:0xf bank_mask:0xf
    v_add_f32_dpp v75, v22, v21 row_ror:12 row_mask:0xf bank_mask:0xf
    v_add_f32_dpp v74, v20, v23 row_ror:12 row_mask:0xf bank_mask:0xf
    v_add_f32_dpp v25, v73, v72 row_ror:8 row_mask:0xf bank_mask:0x4
    s_nop 1
    v_add_f32_dpp v25, v75, v74 row_ror:8 row_mask:0xf bank_mask:0x8
    v_cvt_pk_bf16_f32 v27, v24, v25
    v_mov_b32 v28, v29
    v_mov_b32 v29, v30
    v_mov_b32 v30, v31
    v_cndmask_b32 v31, v26, v27, s[90:91]
    s_add_u32 s88, s88, 1
    s_and_b32 s84, s88, 3
    s_cbranch_scc1 L_kloop
    v_add_u32 v33, 4096, v33
    v_add_u32 v7, 4, v7
    ds_write_b128 v33, v[28:31] offset:12288
    s_waitcnt lgkmcnt(0)
    s_mov_b64 exec, 1
    ds_add_u32 v7, v34 offset:28
    s_mov_b64 exec, -1
    s_cmp_lt_u32 s88, 8
    s_cbranch_scc1 L_kloop
    s_cmp_eq_u32 s85, 0
    s_cbranch_scc1 L_wf0go
    s_mov_b32 s89, 400000
L_wf0:
    ds_read_b32 v72, v35 offset:40
    s_sub_u32 s89, s89, 1
    s_waitcnt lgkmcnt(0)
    v_readfirstlane_b32 s84, v72
    s_cmp_eq_u32 s89, 0
    s_cbranch_scc1 L_wf0go
    s_cmp_lt_u32 s84, 1
    s_cbranch_scc1 L_wf0
L_wf0go:
    ds_read_b128 v[36:39], v32 offset:16384
    s_waitcnt lgkmcnt(0)
    v_lshlrev_b32 v72, 16, v36
    v_and_b32 v73, 0xffff0000, v36
    v_lshlrev_b32 v74, 16, v37
    v_and_b32 v75, 0xffff0000, v37
    v_lshlrev_b32 v76, 16, v38
    v_and_b32 v77, 0xffff0000, v38
    v_lshlrev_b32 v78, 16, v39
    v_and_b32 v79, 0xffff0000, v39
    v_max3_f32 v80, v72, v73, v74
    v_max3_f32 v81, v75, v76, v77
    v_max3_f32 v80, v80, v78, v79
    v_max_f32 v80, v80, v81
    s_nop 1
    v_max_f32_dpp v80, v80, v80 row_ror:2 row_mask:0xf bank_mask:0xf
    s_nop 1
    v_max_f32_dpp v80, v80, v80 row_ror:4 row_mask:0xf bank_mask:0xf
    s_nop 1
    v_max_f32_dpp v80, v80, v80 row_ror:8 row_mask:0xf bank_mask:0xf
    v_mov_b32 v81, v80
    s_nop 1
    v_permlane16_swap_b32 v80, v81
    v_max_f32 v80, v80, v81
    v_mov_b32 v81, v80
    s_nop 1
    v_permlane32_swap_b32 v80, v81
    v_max_f32 v80, v80, v81
    s_mov_b32 s89, 0x3db8aa3b
    v_mov_b32 v88, v80
    v_sub_f32 v72, v72, v88
    v_sub_f32 v73, v73, v88
    v_sub_f32 v74, v74, v88
    v_sub_f32 v75, v75, v88
    v_sub_f32 v76, v76, v88
    v_sub_f32 v77, v77, v88
    v_sub_f32 v78, v78, v88
    v_sub_f32 v79, v79, v88
    v_mul_f32 v72, s89, v72
    v_mul_f32 v73, s89, v73
    v_mul_f32 v74, s89, v74
    v_mul_f32 v75, s89, v75
    v_mul_f32 v76, s89, v76
    v_mul_f32 v77, s89, v77
    v_mul_f32 v78, s89, v78
    v_mul_f32 v79, s89, v79
    v_exp_f32 v72, v72
    v_exp_f32 v73, v73
    v_exp_f32 v74, v74
    v_exp_f32 v75, v75
    v_exp_f32 v76, v76
    v_exp_f32 v77, v77
    v_exp_f32 v78, v78
    v_exp_f32 v79, v79
    v_cvt_pk_bf16_f32 v40, v72, v73
    v_cvt_pk_bf16_f32 v41, v74, v75
    v_cvt_pk_bf16_f32 v42, v76, v77
    v_cvt_pk_bf16_f32 v43, v78, v79
    v_add_f32 v72, v72, v73
    v_add_f32 v74, v74, v75
    v_add_f32 v76, v76, v77
    v_add_f32 v78, v78, v79
    v_add_f32 v72, v72, v74
    v_add_f32 v76, v76, v78
    v_add_f32 v89, v72, v76
    s_lshl_b32 s92, s3, 11
    v_add_u32 v6, s92, v4
    s_mov_b32 s88, 0
L_vloop:
    s_nop 1
    v_mov_b32_dpp v44, v40 row_newbcast:0 row_mask:0xf bank_mask:0x3
    v_mov_b32_dpp v45, v40 row_newbcast:4 row_mask:0xf bank_mask:0x3
    s_nop 0
    v_mov_b32_dpp v44, v40 row_newbcast:1 row_mask:0xf bank_mask:0xc
    v_mov_b32_dpp v45, v40 row_newbcast:5 row_mask:0xf bank_mask:0xc
    v_perm_b32 v48, v44, v44, v56
    v_perm_b32 v49, v44, v44, v57
    v_perm_b32 v50, v44, v44, v58
    v_perm_b32 v51, v44, v44, v59
    v_perm_b32 v52, v45, v45, v56
    v_perm_b32 v53, v45, v45, v57
    v_perm_b32 v54, v45, v45, v58
    v_perm_b32 v55, v45, v45, v59
    s_waitcnt vmcnt(5)
    buffer_load_dwordx4 v[144:147], v2, s[44:47], s75 offen offset:0 nt
    buffer_load_dwordx4 v[148:151], v2, s[44:47], s75 offen offset:256 nt
    buffer_load_dwordx4 v[152:155], v2, s[44:47], s75 offen offset:2048 nt
    buffer_load_dwordx4 v[156:159], v2, s[44:47], s75 offen offset:2304 nt
    v_mfma_f32_16x16x32_bf16 v[64:67], v[48:51], v[96:99], v[64:67]
    v_mfma_f32_16x16x32_bf16 v[68:71], v[48:51], v[100:103], v[68:71]
    v_mfma_f32_16x16x32_bf16 v[64:67], v[52:55], v[104:107], v[64:67]
    v_mfma_f32_16x16x32_bf16 v[68:71], v[52:55], v[108:111], v[68:71]
    v_mov_b32_dpp v46, v40 row_newbcast:8 row_mask:0xf bank_mask:0x3
    v_mov_b32_dpp v47, v40 row_newbcast:12 row_mask:0xf bank_mask:0x3
    s_nop 0
    v_mov_b32_dpp v46, v40 row_newbcast:9 row_mask:0xf bank_mask:0xc
    v_mov_b32_dpp v47, v40 row_newbcast:13 row_mask:0xf bank_mask:0xc
    v_perm_b32 v48, v46, v46, v56
    v_perm_b32 v49, v46, v46, v57
    v_perm_b32 v50, v46, v46, v58
    v_perm_b32 v51, v46, v46, v59
    v_perm_b32 v52, v47, v47, v56
    v_perm_b32 v53, v47, v47, v57
    v_perm_b32 v54, v47, v47, v58
    v_perm_b32 v55, v47, v47, v59
    s_waitcnt vmcnt(5)
    buffer_load_dwordx4 v[96:99], v2, s[44:47], s76 offen offset:0 nt
    buffer_load_dwordx4 v[100:103], v2, s[44:47], s76 offen offset:256 nt
    buffer_load_dwordx4 v[104:107], v2, s[44:47], s76 offen offset:2048 nt
    buffer_load_dwordx4 v[108:111], v2, s[44:47], s76 offen offset:2304 nt
    v_mfma_f32_16x16x32_bf16 v[64:67], v[48:51], v[112:115], v[64:67]
    v_mfma_f32_16x16x32_bf16 v[68:71], v[48:51], v[116:119], v[68:71]
    v_mfma_f32_16x16x32_bf16 v[64:67], v[52:55], v[120:123], v[64:67]
    v_mfma_f32_16x16x32_bf16 v[68:71], v[52:55], v[124:127], v[68:71]
    v_perm_b32 v48, v44, v44, v60
    v_perm_b32 v49, v44, v44, v61
    v_perm_b32 v50, v44, v44, v62
    v_perm_b32 v51, v44, v44, v63
    v_perm_b32 v52, v45, v45, v60
    v_perm_b32 v53, v45, v45, v61
    v_perm_b32 v54, v45, v45, v62
    v_perm_b32 v55, v45, v45, v63
    s_waitcnt vmcnt(5)
    buffer_load_dwordx4 v[112:115], v2, s[44:47], s77 offen offset:0 nt
    buffer_load_dwordx4 v[116:119], v2, s[44:47], s77 offen offset:256 nt
    buffer_load_dwordx4 v[120:123], v2, s[44:47], s77 offen offset:2048 nt
    buffer_load_dwordx4 v[124:127], v2, s[44:47], s77 offen offset:2304 nt
    v_mfma_f32_16x16x32_bf16 v[64:67], v[48:51], v[128:131], v[64:67]
    v_mfma_f32_16x16x32_bf16 v[68:71], v[48:51], v[132:135], v[68:71]
    v_mfma_f32_16x16x32_bf16 v[64:67], v[52:55], v[136:139], v[64:67]
    v_mfma_f32_16x16x32_bf16 v[68:71], v[52:55], v[140:143], v[68:71]
    v_perm_b32 v48, v46, v46, v60
    v_perm_b32 v49, v46, v46, v61
    v_perm_b32 v50, v46, v46, v62
    v_perm_b32 v51, v46, v46, v63
    v_perm_b32 v52, v47, v47, v60
    v_perm_b32 v53, v47, v47, v61
    v_perm_b32 v54, v47, v47, v62
    v_perm_b32 v55, v47, v47, v63
    s_waitcnt vmcnt(5)
    buffer_load_dwordx4 v[128:131], v2, s[44:47], s78 offen offset:0 nt
    buffer_load_dwordx4 v[132:135], v2, s[44:47], s78 offen offset:256 nt
    buffer_load_dwordx4 v[136:139], v2, s[44:47], s78 offen offset:2048 nt
    buffer_load_dwordx4 v[140:143], v2, s[44:47], s78 offen offset:2304 nt
    v_mfma_f32_16x16x32_bf16 v[64:67], v[48:51], v[144:147], v[64:67]
    v_mfma_f32_16x16x32_bf16 v[68:71], v[48:51], v[148:151], v[68:71]
    v_mfma_f32_16x16x32_bf16 v[64:67], v[52:55], v[152:155], v[64:67]
    v_mfma_f32_16x16x32_bf16 v[68:71], v[52:55], v[156:159], v[68:71]
    v_mov_b32_dpp v44, v40 row_newbcast:2 row_mask:0xf bank_mask:0x3
    v_mov_b32_dpp v45, v40 row_newbcast:6 row_mask:0xf bank_mask:0x3
    s_nop 0
    v_mov_b32_dpp v44, v40 row_newbcast:3 row_mask:0xf bank_mask:0xc
    v_mov_b32_dpp v45, v40 row_newbcast:7 row_mask:0xf bank_mask:0xc
    v_perm_b32 v48, v44, v44, v56
    v_perm_b32 v49, v44, v44, v57
    v_perm_b32 v50, v44, v44, v58
    v_perm_b32 v51, v44, v44, v59
    v_perm_b32 v52, v45, v45, v56
    v_perm_b32 v53, v45, v45, v57
    v_perm_b32 v54, v45, v45, v58
    v_perm_b32 v55, v45, v45, v59
    s_waitcnt vmcnt(5)
    buffer_load_dwordx4 v[144:147], v2, s[44:47], s79 offen offset:0 nt
    buffer_load_dwordx4 v[148:151], v2, s[44:47], s79 offen offset:256 nt
    buffer_load_dwordx4 v[152:155], v2, s[44:47], s79 offen offset:2048 nt
    buffer_load_dwordx4 v[156:159], v2, s[44:47], s79 offen offset:2304 nt
    v_mfma_f32_16x16x32_bf16 v[64:67], v[48:51], v[96:99], v[64:67]
    v_mfma_f32_16x16x32_bf16 v[68:71], v[48:51], v[100:103], v[68:71]
    v_mfma_f32_16x16x32_bf16 v[64:67], v[52:55], v[104:107], v[64:67]
    v_mfma_f32_16x16x32_bf16 v[68:71], v[52:55], v[108:111], v[68:71]
    v_mov_b32_dpp v46, v40 row_newbcast:10 row_mask:0xf bank_mask:0x3
    v_mov_b32_dpp v47, v40 row_newbcast:14 row_mask:0xf bank_mask:0x3
    s_nop 0
    v_mov_b32_dpp v46, v40 row_newbcast:11 row_mask:0xf bank_mask:0xc
    v_mov_b32_dpp v47, v40 row_newbcast:15 row_mask:0xf bank_mask:0xc
    v_perm_b32 v48, v46, v46, v56
    v_perm_b32 v49, v46, v46, v57
    v_perm_b32 v50, v46, v46, v58
    v_perm_b32 v51, v46, v46, v59
    v_perm_b32 v52, v47, v47, v56
    v_perm_b32 v53, v47, v47, v57
    v_perm_b32 v54, v47, v47, v58
    v_perm_b32 v55, v47, v47, v59
    v_add_u32 v2, 0x400000, v2
    s_waitcnt vmcnt(5)
    buffer_load_dwordx4 v[96:99], v2, s[44:47], s72 offen offset:0 nt
    buffer_load_dwordx4 v[100:103], v2, s[44:47], s72 offen offset:256 nt
    buffer_load_dwordx4 v[104:107], v2, s[44:47], s72 offen offset:2048 nt
    buffer_load_dwordx4 v[108:111], v2, s[44:47], s72 offen offset:2304 nt
    v_mfma_f32_16x16x32_bf16 v[64:67], v[48:51], v[112:115], v[64:67]
    v_mfma_f32_16x16x32_bf16 v[68:71], v[48:51], v[116:119], v[68:71]
    v_mfma_f32_16x16x32_bf16 v[64:67], v[52:55], v[120:123], v[64:67]
    v_mfma_f32_16x16x32_bf16 v[68:71], v[52:55], v[124:127], v[68:71]
    v_perm_b32 v48, v44, v44, v60
    v_perm_b32 v49, v44, v44, v61
    v_perm_b32 v50, v44, v44, v62
    v_perm_b32 v51, v44, v44, v63
    v_perm_b32 v52, v45, v45, v60
    v_perm_b32 v53, v45, v45, v61
    v_perm_b32 v54, v45, v45, v62
    v_perm_b32 v55, v45, v45, v63
    s_waitcnt vmcnt(5)
    buffer_load_dwordx4 v[112:115], v2, s[44:47], s73 offen offset:0 nt
    buffer_load_dwordx4 v[116:119], v2, s[44:47], s73 offen offset:256 nt
    buffer_load_dwordx4 v[120:123], v2, s[44:47], s73 offen offset:2048 nt
    buffer_load_dwordx4 v[124:127], v2, s[44:47], s73 offen offset:2304 nt
    v_mfma_f32_16x16x32_bf16 v[64:67], v[48:51], v[128:131], v[64:67]
    v_mfma_f32_16x16x32_bf16 v[68:71], v[48:51], v[132:135], v[68:71]
    v_mfma_f32_16x16x32_bf16 v[64:67], v[52:55], v[136:139], v[64:67]
    v_mfma_f32_16x16x32_bf16 v[68:71], v[52:55], v[140:143], v[68:71]
    v_perm_b32 v48, v46, v46, v60
    v_perm_b32 v49, v46, v46, v61
    v_perm_b32 v50, v46, v46, v62
    v_perm_b32 v51, v46, v46, v63
    v_perm_b32 v52, v47, v47, v60
    v_perm_b32 v53, v47, v47, v61
    v_perm_b32 v54, v47, v47, v62
    v_perm_b32 v55, v47, v47, v63
    s_waitcnt vmcnt(5)
    buffer_load_dwordx4 v[128:131], v2, s[44:47], s74 offen offset:0 nt
    buffer_load_dwordx4 v[132:135], v2, s[44:47], s74 offen offset:256 nt
    buffer_load_dwordx4 v[136:139], v2, s[44:47], s74 offen offset:2048 nt
    buffer_load_dwordx4 v[140:143], v2, s[44:47], s74 offen offset:2304 nt
    v_mfma_f32_16x16x32_bf16 v[64:67], v[48:51], v[144:147], v[64:67]
    v_mfma_f32_16x16x32_bf16 v[68:71], v[48:51], v[148:151], v[68:71]
    v_mfma_f32_16x16x32_bf16 v[64:67], v[52:55], v[152:155], v[64:67]
    v_mfma_f32_16x16x32_bf16 v[68:71], v[52:55], v[156:159], v[68:71]
    v_mov_b32 v40, v41
    v_mov_b32 v41, v42
    v_mov_b32 v42, v43
    s_add_u32 s88, s88, 1
    s_and_b32 s84, s88, 3
    s_cbranch_scc1 L_vloop
    s_cmp_eq_u32 s88, 8
    s_cbranch_scc1 L_vdone
    s_cmp_eq_u32 s85, 0
    s_cbranch_scc1 L_wf1go
    s_mov_b32 s89, 400000
L_wf1:
    ds_read_b32 v72, v35 offset:44
    s_sub_u32 s89, s89, 1
    s_waitcnt lgkmcnt(0)
    v_readfirstlane_b32 s84, v72
    s_cmp_eq_u32 s89, 0
    s_cbranch_scc1 L_wf1go
    s_cmp_lt_u32 s84, 1
    s_cbranch_scc1 L_wf1
L_wf1go:
    ds_read_b128 v[36:39], v32 offset:20480
    s_waitcnt lgkmcnt(0)
    v_lshlrev_b32 v72, 16, v36
    v_and_b32 v73, 0xffff0000, v36
    v_lshlrev_b32 v74, 16, v37
    v_and_b32 v75, 0xffff0000, v37
    v_lshlrev_b32 v76, 16, v38
    v_and_b32 v77, 0xffff0000, v38
    v_lshlrev_b32 v78, 16, v39
    v_and_b32 v79, 0xffff0000, v39
    v_max3_f32 v80, v72, v73, v74
    v_max3_f32 v81, v75, v76, v77
    v_max3_f32 v80, v80, v78, v79
    v_max_f32 v80, v80, v81
    s_nop 1
    v_max_f32_dpp v80, v80, v80 row_ror:2 row_mask:0xf bank_mask:0xf
    s_nop 1
    v_max_f32_dpp v80, v80, v80 row_ror:4 row_mask:0xf bank_mask:0xf
    s_nop 1
    v_max_f32_dpp v80, v80, v80 row_ror:8 row_mask:0xf bank_mask:0xf
    v_mov_b32 v81, v80
    s_nop 1
    v_permlane16_swap_b32 v80, v81
    v_max_f32 v80, v80, v81
    v_mov_b32 v81, v80
    s_nop 1
    v_permlane32_swap_b32 v80, v81
    v_max_f32 v80, v80, v81
    s_mov_b32 s89, 0x3db8aa3b
    v_max_f32 v80, v80, v88
    v_sub_f32 v81, v88, v80
    v_mul_f32 v81, s89, v81
    v_exp_f32 v81, v81
    v_mov_b32 v88, v80
    v_mul_f32 v89, v89, v81
    v_readlane_b32 s92, v81, 0
    v_readlane_b32 s93, v81, 1
    s_nop 0
    v_mov_b32 v82, s92
    s_mov_b32 exec_lo, 0
    v_mov_b32 v82, s93
    s_mov_b32 exec_lo, -1
    v_mul_f32 v64, v64, v82
    v_mul_f32 v65, v65, v82
    v_mul_f32 v66, v66, v82
    v_mul_f32 v67, v67, v82
    v_mul_f32 v68, v68, v82
    v_mul_f32 v69, v69, v82
    v_mul_f32 v70, v70, v82
    v_mul_f32 v71, v71, v82
    v_sub_f32 v72, v72, v88
    v_sub_f32 v73, v73, v88
    v_sub_f32 v74, v74, v88
    v_sub_f32 v75, v75, v88
    v_sub_f32 v76, v76, v88
    v_sub_f32 v77, v77, v88
    v_sub_f32 v78, v78, v88
    v_sub_f32 v79, v79, v88
    v_mul_f32 v72, s89, v72
    v_mul_f32 v73, s89, v73
    v_mul_f32 v74, s89, v74
    v_mul_f32 v75, s89, v75
    v_mul_f32 v76, s89, v76
    v_mul_f32 v77, s89, v77
    v_mul_f32 v78, s89, v78
    v_mul_f32 v79, s89, v79
    v_exp_f32 v72, v72
    v_exp_f32 v73, v73
    v_exp_f32 v74, v74
    v_exp_f32 v75, v75
    v_exp_f32 v76, v76
    v_exp_f32 v77, v77
    v_exp_f32 v78, v78
    v_exp_f32 v79, v79
    v_cvt_pk_bf16_f32 v40, v72, v73
    v_cvt_pk_bf16_f32 v41, v74, v75
    v_cvt_pk_bf16_f32 v42, v76, v77
    v_cvt_pk_bf16_f32 v43, v78, v79
    v_add_f32 v72, v72, v73
    v_add_f32 v74, v74, v75
    v_add_f32 v76, v76, v77
    v_add_f32 v78, v78, v79
    v_add_f32 v72, v72, v74
    v_add_f32 v76, v76, v78
    v_add_f32 v72, v72, v76
    v_add_f32 v89, v89, v72
    s_nop 1
    v_add_f32_dpp v89, v89, v89 row_ror:2 row_mask:0xf bank_mask:0xf
    s_nop 1
    v_add_f32_dpp v89, v89, v89 row_ror:4 row_mask:0xf bank_mask:0xf
    s_nop 1
    v_add_f32_dpp v89, v89, v89 row_ror:8 row_mask:0xf bank_mask:0xf
    v_mov_b32 v81, v89
    s_nop 1
    v_permlane16_swap_b32 v89, v81
    v_add_f32 v89, v89, v81
    v_mov_b32 v81, v89
    s_nop 1
    v_permlane32_swap_b32 v89, v81
    v_add_f32 v89, v89, v81
    s_lshl_b32 s92, s3, 4
    v_lshl_add_u32 v81, v1, 2, s92
    s_mov_b64 exec, 3
    ds_write_b32 v81, v88 offset:12288
    ds_write_b32 v81, v89 offset:12296
    s_mov_b64 exec, 1
    s_waitcnt lgkmcnt(0)
    ds_add_u32 v35, v34 offset:28
    s_mov_b64 exec, -1
    s_branch L_vloop
L_tov:
    s_mov_b32 s89, 400000
L_wv:
    ds_read_b32 v76, v35 offset:20
    s_sub_u32 s89, s89, 1
    s_waitcnt lgkmcnt(0)
    v_readfirstlane_b32 s84, v76
    s_cmp_eq_u32 s89, 0
    s_cbranch_scc1 L_wvgo
    s_cmp_lt_u32 s84, 1
    s_cbranch_scc1 L_wv
L_wvgo:
    s_xor_b32 s85, s84, s83
    s_and_b32 s85, s85, 7
    s_cselect_b32 s84, 8192, 0
    s_sub_u32 s84, s84, 4096
    v_add_u32 v32, s84, v33
    s_lshl_b32 s84, s85, 12
    s_xor_b32 s72, s72, s84
    s_xor_b32 s73, s73, s84
    s_xor_b32 s74, s74, s84
    s_xor_b32 s75, s75, s84
    s_xor_b32 s76, s76, s84
    s_xor_b32 s77, s77, s84
    s_xor_b32 s78, s78, s84
    s_xor_b32 s79, s79, s84
    s_mov_b32 s44, s48
    s_mov_b32 s45, s49
    v_mov_b32 v2, v3
    s_branch L_tovback
L_vdone:
    s_nop 3
    ds_write_b128 v6, v[64:67] offset:4096
    ds_write_b128 v6, v[68:71] offset:5120
    s_waitcnt lgkmcnt(0)
    s_barrier
    s_endpgm
L_helper:
    s_setprio 2
    v_lshrrev_b32 v6, 4, v1
    v_and_b32 v7, 15, v1
    s_lshr_b32 s81, s2, 3
    s_mul_i32 s88, s5, 200704
    s_lshl_b32 s87, s81, 7
    s_add_u32 s88, s88, s87
    s_cmp_lt_u32 s81, 28
    s_cselect_b32 s88, s88, 0x400000
    s_cselect_b32 s87, s2, 0x40000
    v_lshrrev_b32 v12, 3, v1
    v_mul_u32_u24 v13, 3584, v12
    v_and_b32 v14, 7, v1
    v_lshl_add_u32 v13, v14, 4, v13
    v_mul_u32_u24 v16, 1792, v6
    v_lshl_add_u32 v16, v7, 4, v16
    v_lshlrev_b32 v17, 2, v6
    v_mul_u32_u24 v18, 3584, v6
    v_lshl_add_u32 v18, v7, 4, v18
    v_lshlrev_b32 v159, 1, v6
    v_and_b32 v158, 1, v1
    v_lshl_add_u32 v159, v158, 3, v159
    v_mov_b32 v157, 0
    v_mov_b32 v158, 0
    s_waitcnt lgkmcnt(0)
    s_mov_b32 s52, s40
    s_mov_b32 s53, s41
    s_mov_b32 s54, 16777216
    s_mov_b32 s55, 0x00020000
    s_mov_b32 s56, s38
    s_mov_b32 s57, s39
    s_mov_b32 s58, 256
    s_mov_b32 s59, 0x00020000
    s_mov_b32 s64, s28
    s_mov_b32 s65, s29
    s_mov_b32 s66, 1605632
    s_mov_b32 s67, 0x00020000
    s_mov_b32 s68, s32
    s_mov_b32 s69, s33
    s_mov_b32 s70, 1605632
    s_mov_b32 s71, 0x00020000
    s_mov_b32 s72, s30
    s_mov_b32 s73, s31
    s_mov_b32 s74, 3584
    s_mov_b32 s75, 0x00020000
    s_mov_b32 s76, s24
    s_mov_b32 s77, s25
    s_mov_b32 s78, 3670016
    s_mov_b32 s79, 0x00020000
    s_mov_b32 s60, s16
    s_mov_b32 s61, s17
    s_mov_b32 s62, 896
    s_mov_b32 s63, 0x00020000
    s_mov_b32 s44, s34
    s_mov_b32 s45, s35
    s_mov_b32 s46, 896
    s_mov_b32 s47, 0x00020000
    s_mov_b32 s89, 400000
L_whs:
    ds_read_b32 v19, v157 offset:52
    s_sub_u32 s89, s89, 1
    s_waitcnt lgkmcnt(0)
    v_readfirstlane_b32 s81, v19
    s_cmp_eq_u32 s89, 0
    s_cbranch_scc1 L_whsgo
    s_cmp_lt_u32 s81, 1
    s_cbranch_scc1 L_whs
L_whsgo:
    s_mov_b32 s89, 400000
L_whs2:
    ds_read_b32 v19, v157 offset:56
    s_sub_u32 s89, s89, 1
    s_waitcnt lgkmcnt(0)
    v_readfirstlane_b32 s81, v19
    s_cmp_eq_u32 s89, 0
    s_cbranch_scc1 L_whs2go
    s_cmp_lt_u32 s81, 1
    s_cbranch_scc1 L_whs2
L_whs2go:
    buffer_load_dword v31, off, s[52:55], s51 sc0 sc1
    s_add_u32 s81, s88, 0
    buffer_load_dwordx4 v[96:99], v13, s[64:67], s81 offen nt
    s_add_u32 s81, s88, 28672
    buffer_load_dwordx4 v[100:103], v13, s[64:67], s81 offen nt
    s_add_u32 s81, s88, 57344
    buffer_load_dwordx4 v[104:107], v13, s[64:67], s81 offen nt
    s_add_u32 s81, s88, 86016
    buffer_load_dwordx4 v[108:111], v13, s[64:67], s81 offen nt
    s_add_u32 s81, s88, 114688
    buffer_load_dwordx4 v[112:115], v13, s[64:67], s81 offen nt
    s_add_u32 s81, s88, 143360
    buffer_load_dwordx4 v[116:119], v13, s[64:67], s81 offen nt
    s_add_u32 s81, s88, 172032
    buffer_load_dwordx4 v[120:123], v13, s[64:67], s81 offen nt
    s_mul_i32 s81, s87, 7168
    buffer_load_dwordx4 v[124:127], v16, s[68:71], s81 offen offset:0 nt
    buffer_load_dwordx4 v[128:131], v16, s[68:71], s81 offen offset:256 nt
    buffer_load_dwordx4 v[132:135], v16, s[68:71], s81 offen offset:512 nt
    buffer_load_dwordx4 v[136:139], v16, s[68:71], s81 offen offset:768 nt
    buffer_load_dwordx4 v[140:143], v16, s[68:71], s81 offen offset:896 nt
    buffer_load_dwordx4 v[144:147], v16, s[68:71], s81 offen offset:1152 nt
    buffer_load_dwordx4 v[148:151], v16, s[68:71], s81 offen offset:1408 nt
    buffer_load_dwordx4 v[152:155], v16, s[68:71], s81 offen offset:1664 nt
    s_lshl_b32 s81, s87, 4
    buffer_load_dword v156, v17, s[72:75], s81 offen
    s_mul_i32 s81, s2, 14336
    buffer_load_dwordx4 v[160:163], v18, s[76:79], s81 offen offset:0 nt
    buffer_load_dwordx4 v[164:167], v18, s[76:79], s81 offen offset:256 nt
    buffer_load_dwordx4 v[168:171], v18, s[76:79], s81 offen offset:512 nt
    buffer_load_dwordx4 v[172:175], v18, s[76:79], s81 offen offset:768 nt
    buffer_load_dwordx4 v[176:179], v18, s[76:79], s81 offen offset:896 nt
    buffer_load_dwordx4 v[180:183], v18, s[76:79], s81 offen offset:1152 nt
    buffer_load_dwordx4 v[184:187], v18, s[76:79], s81 offen offset:1408 nt
    buffer_load_dwordx4 v[188:191], v18, s[76:79], s81 offen offset:1664 nt
    buffer_load_dwordx4 v[192:195], v18, s[76:79], s81 offen offset:1792 nt
    buffer_load_dwordx4 v[196:199], v18, s[76:79], s81 offen offset:2048 nt
    buffer_load_dwordx4 v[200:203], v18, s[76:79], s81 offen offset:2304 nt
    buffer_load_dwordx4 v[204:207], v18, s[76:79], s81 offen offset:2560 nt
    buffer_load_dwordx4 v[208:211], v18, s[76:79], s81 offen offset:2688 nt
    buffer_load_dwordx4 v[212:215], v18, s[76:79], s81 offen offset:2944 nt
    buffer_load_dwordx4 v[216:219], v18, s[76:79], s81 offen offset:3200 nt
    buffer_load_dwordx4 v[220:223], v18, s[76:79], s81 offen offset:3456 nt
    s_lshl_b32 s87, s2, 4
    buffer_load_short_d16_hi v157, v159, s[60:63], s87 offen
    buffer_load_short_d16_hi v158, v159, s[44:47], s87 offen
    v_mov_b32 v14, 0
    s_mov_b32 s89, 400000
L_whq:
    s_sleep 2
    ds_read_b32 v13, v14 offset:24
    s_sub_u32 s89, s89, 1
    s_waitcnt lgkmcnt(0)
    v_readfirstlane_b32 s81, v13
    s_cmp_eq_u32 s89, 0
    s_cbranch_scc1 L_whqgo
    s_cmp_lt_u32 s81, 1
    s_cbranch_scc1 L_whq
L_whqgo:
    s_mul_i32 s81, s5, 224
    v_lshl_add_u32 v12, v12, 2, s81
    ds_read_b32 v20, v12 offset:12544
    ds_read_b32 v21, v12 offset:12576
    ds_read_b32 v22, v12 offset:12608
    ds_read_b32 v23, v12 offset:12640
    ds_read_b32 v24, v12 offset:12672
    ds_read_b32 v25, v12 offset:12704
    ds_read_b32 v26, v12 offset:12736
    s_waitcnt vmcnt(0)
    v_readfirstlane_b32 s50, v31
    s_nop 0
    s_and_b32 s50, s50, -4
    s_mul_i32 s50, s50, 0x2c9277b5
    s_add_u32 s50, s50, 0x3c6ef35c
    v_mov_b32 v16, -1
    v_mov_b32 v17, -1
    v_mov_b32 v18, -1
    v_mov_b32 v19, -1
    s_lshl_b32 s82, s2, 12
    s_add_u32 s82, s82, 1048576
    buffer_store_dwordx4 v[16:19], v4, s[52:55], s82 offen offset:0 sc0 sc1
    buffer_store_dwordx4 v[16:19], v4, s[52:55], s82 offen offset:1024 sc0 sc1
    s_lshl_b32 s83, s2, 13
    s_add_u32 s83, s83, 524288
    s_lshl_b32 s81, s2, 11
    s_add_u32 s81, s81, 524288
    buffer_store_dwordx4 v[16:19], v4, s[52:55], s81 offen offset:0 sc0 sc1
    buffer_store_dwordx4 v[16:19], v4, s[52:55], s81 offen offset:1024 sc0 sc1
    s_waitcnt lgkmcnt(0)
    v_lshlrev_b32 v30, 16, v96
    v_and_b32 v96, 0xffff0000, v96
    v_mul_f32 v8, v30, v20
    v_mul_f32 v9, v96, v20
    v_lshlrev_b32 v30, 16, v97
    v_and_b32 v97, 0xffff0000, v97
    v_mul_f32 v10, v30, v20
    v_mul_f32 v11, v97, v20
    v_lshlrev_b32 v30, 16, v98
    v_and_b32 v98, 0xffff0000, v98
    v_mul_f32 v12, v30, v20
    v_mul_f32 v13, v98, v20
    v_lshlrev_b32 v30, 16, v99
    v_and_b32 v99, 0xffff0000, v99
    v_mul_f32 v14, v30, v20
    v_mul_f32 v15, v99, v20
    v_lshlrev_b32 v30, 16, v100
    v_and_b32 v100, 0xffff0000, v100
    v_fmac_f32 v8, v30, v21
    v_fmac_f32 v9, v100, v21
    v_lshlrev_b32 v30, 16, v101
    v_and_b32 v101, 0xffff0000, v101
    v_fmac_f32 v10, v30, v21
    v_fmac_f32 v11, v101, v21
    v_lshlrev_b32 v30, 16, v102
    v_and_b32 v102, 0xffff0000, v102
    v_fmac_f32 v12, v30, v21
    v_fmac_f32 v13, v102, v21
    v_lshlrev_b32 v30, 16, v103
    v_and_b32 v103, 0xffff0000, v103
    v_fmac_f32 v14, v30, v21
    v_fmac_f32 v15, v103, v21
    v_lshlrev_b32 v30, 16, v104
    v_and_b32 v104, 0xffff0000, v104
    v_fmac_f32 v8, v30, v22
    v_fmac_f32 v9, v104, v22
    v_lshlrev_b32 v30, 16, v105
    v_and_b32 v105, 0xffff0000, v105
    v_fmac_f32 v10, v30, v22
    v_fmac_f32 v11, v105, v22
    v_lshlrev_b32 v30, 16, v106
    v_and_b32 v106, 0xffff0000, v106
    v_fmac_f32 v12, v30, v22
    v_fmac_f32 v13, v106, v22
    v_lshlrev_b32 v30, 16, v107
    v_and_b32 v107, 0xffff0000, v107
    v_fmac_f32 v14, v30, v22
    v_fmac_f32 v15, v107, v22
    v_lshlrev_b32 v30, 16, v108
    v_and_b32 v108, 0xffff0000, v108
    v_fmac_f32 v8, v30, v23
    v_fmac_f32 v9, v108, v23
    v_lshlrev_b32 v30, 16, v109
    v_and_b32 v109, 0xffff0000, v109
    v_fmac_f32 v10, v30, v23
    v_fmac_f32 v11, v109, v23
    v_lshlrev_b32 v30, 16, v110
    v_and_b32 v110, 0xffff0000, v110
    v_fmac_f32 v12, v30, v23
    v_fmac_f32 v13, v110, v23
    v_lshlrev_b32 v30, 16, v111
    v_and_b32 v111, 0xffff0000, v111
    v_fmac_f32 v14, v30, v23
    v_fmac_f32 v15, v111, v23
    v_lshlrev_b32 v30, 16, v112
    v_and_b32 v112, 0xffff0000, v112
    v_fmac_f32 v8, v30, v24
    v_fmac_f32 v9, v112, v24
    v_lshlrev_b32 v30, 16, v113
    v_and_b32 v113, 0xffff0000, v113
    v_fmac_f32 v10, v30, v24
    v_fmac_f32 v11, v113, v24
    v_lshlrev_b32 v30, 16, v114
    v_and_b32 v114, 0xffff0000, v114
    v_fmac_f32 v12, v30, v24
    v_fmac_f32 v13, v114, v24
    v_lshlrev_b32 v30, 16, v115
    v_and_b32 v115, 0xffff0000, v115
    v_fmac_f32 v14, v30, v24
    v_fmac_f32 v15, v115, v24
    v_lshlrev_b32 v30, 16, v116
    v_and_b32 v116, 0xffff0000, v116
    v_fmac_f32 v8, v30, v25
    v_fmac_f32 v9, v116, v25
    v_lshlrev_b32 v30, 16, v117
    v_and_b32 v117, 0xffff0000, v117
    v_fmac_f32 v10, v30, v25
    v_fmac_f32 v11, v117, v25
    v_lshlrev_b32 v30, 16, v118
    v_and_b32 v118, 0xffff0000, v118
    v_fmac_f32 v12, v30, v25
    v_fmac_f32 v13, v118, v25
    v_lshlrev_b32 v30, 16, v119
    v_and_b32 v119, 0xffff0000, v119
    v_fmac_f32 v14, v30, v25
    v_fmac_f32 v15, v119, v25
    v_lshlrev_b32 v30, 16, v120
    v_and_b32 v120, 0xffff0000, v120
    v_fmac_f32 v8, v30, v26
    v_fmac_f32 v9, v120, v26
    v_lshlrev_b32 v30, 16, v121
    v_and_b32 v121, 0xffff0000, v121
    v_fmac_f32 v10, v30, v26
    v_fmac_f32 v11, v121, v26
    v_lshlrev_b32 v30, 16, v122
    v_and_b32 v122, 0xffff0000, v122
    v_fmac_f32 v12, v30, v26
    v_fmac_f32 v13, v122, v26
    v_lshlrev_b32 v30, 16, v123
    v_and_b32 v123, 0xffff0000, v123
    v_fmac_f32 v14, v30, v26
    v_fmac_f32 v15, v123, v26
    v_permlane16_swap_b32 v8, v10
    v_permlane16_swap_b32 v12, v14
    v_permlane16_swap_b32 v9, v11
    v_permlane16_swap_b32 v13, v15
    v_add_f32 v8, v8, v10
    v_add_f32 v12, v12, v14
    v_add_f32 v9, v9, v11
    v_add_f32 v13, v13, v15
    v_permlane32_swap_b32 v8, v12
    s_nop 0
    v_permlane32_swap_b32 v9, v13
    v_add_f32 v8, v8, v12
    v_add_f32 v9, v9, v13
    s_nop 0
    v_add_f32_dpp v8, v8, v8 row_ror:8 row_mask:0xf bank_mask:0xf
    v_add_f32_dpp v9, v9, v9 row_ror:8 row_mask:0xf bank_mask:0xf
    v_and_b32 v14, 7, v1
    v_lshlrev_b32 v14, 5, v14
    v_lshl_add_u32 v14, v6, 3, v14
    s_lshl_b32 s81, s2, 8
    s_add_u32 s81, s81, 393216
    s_mov_b32 exec_lo, 0x00ff00ff
    s_mov_b32 exec_hi, 0x00ff00ff
    buffer_store_dwordx2 v[8:9], v14, s[52:55], s81 offen sc0 sc1
    s_mov_b64 exec, -1
    v_mov_b32 v118, 0
    v_mov_b32 v119, 1
    v_mov_b32 v120, s50
    v_add_f32 v113, v157, v158
    s_lshl_b32 s84, s4, 5
    s_mov_b32 s89, 400000
L_whk:
    s_sleep 2
    ds_read_b32 v13, v118 offset:16
    s_sub_u32 s89, s89, 1
    s_waitcnt lgkmcnt(0)
    v_readfirstlane_b32 s48, v13
    s_cmp_eq_u32 s89, 0
    s_cbranch_scc1 L_whkgo
    s_cmp_lt_u32 s48, 1
    s_cbranch_scc1 L_whk
L_whkgo:
    s_waitcnt vmcnt(0)
    s_mov_b64 exec, 1
    buffer_atomic_add v119, off, s[56:59], s84 sc1
    s_mov_b64 exec, -1
    s_mov_b32 s60, s36
    s_mov_b32 s61, s37
    s_mov_b32 s62, 896
    s_mov_b32 s63, 0x00020000
    s_lshr_b32 s64, s5, 1
    s_and_b32 s65, s5, 1
    s_lshl_b32 s65, s65, 2
    s_or_b32 s64, s64, s65
    s_bfe_u32 s65, s4, 0x10001
    s_lshl_b32 s65, s65, 2
    s_xor_b32 s64, s64, s65
    s_lshr_b32 s65, s4, 2
    s_xor_b32 s64, s64, s65
    s_mov_b32 s65, s64
    s_xor_b32 s64, s64, s48
    s_and_b32 s64, s64, 7
    s_lshl_b32 s64, s64, 12
    s_or_b32 s64, s64, 0x1800000
    s_lshl_b32 s81, s4, 25
    s_add_u32 s44, s18, s81
    s_addc_u32 s45, s19, 0
    v_mov_b32 v16, 0
    s_mov_b32 s78, 24
    s_mov_b32 s66, 0x478f80
    s_mov_b32 s67, 0
    s_memtime s[72:73]
    s_waitcnt lgkmcnt(0)
L_lp:
    s_add_u32 s79, s78, s6
    s_and_b32 s79, s79, 3
    s_add_u32 s68, s79, s67
    s_mul_i32 s74, s72, 0x9e3779b1
    s_lshr_b32 s74, s74, 4
    s_and_b32 s74, s74, s66
    s_mul_i32 s79, s79, 0x3000
    s_and_b32 s79, s79, 0x5000
    s_cmp_eq_u32 s68, 3
    s_cselect_b32 s79, 0x5000, s79
    s_cmp_eq_u32 s68, 7
    s_cselect_b32 s79, 0x5000, s79
    s_xor_b32 s74, s74, s64
    s_xor_b32 s74, s74, s79
    s_memtime s[70:71]
    s_load_dword s75, s[44:45], s74
    s_waitcnt lgkmcnt(0)
    s_memtime s[72:73]
    s_lshl_b64 s[76:77], 1, s68
    s_waitcnt lgkmcnt(0)
    s_sub_u32 s70, s72, s70
    s_min_u32 s70, s70, 1800
    s_mov_b64 exec, s[76:77]
    v_add_u32 v16, s70, v16
    s_mov_b64 exec, -1
    s_sub_u32 s78, s78, 1
    s_cmp_lg_u32 s78, 16
    s_cbranch_scc1 L_lp2
    s_add_u32 s44, s20, s81
    s_addc_u32 s45, s21, 0
    s_mov_b32 s89, 400000
L_whv:
    s_sleep 2
    ds_read_b32 v13, v118 offset:48
    s_sub_u32 s89, s89, 1
    s_waitcnt lgkmcnt(0)
    v_readfirstlane_b32 s49, v13
    s_cmp_eq_u32 s89, 0
    s_cbranch_scc1 L_whvgo
    s_cmp_lt_u32 s49, 1
    s_cbranch_scc1 L_whv
L_whvgo:
    s_xor_b32 s64, s65, s49
    s_and_b32 s64, s64, 7
    s_lshl_b32 s64, s64, 12
    s_mov_b32 s66, 0x1c78f80
    s_mov_b32 s67, 4
L_lp2:
    s_cmp_lg_u32 s78, 0
    s_cbranch_scc1 L_lp
    v_readlane_b32 s70, v16, 0
    v_readlane_b32 s71, v16, 1
    v_readlane_b32 s72, v16, 2
    v_readlane_b32 s73, v16, 3
    v_readlane_b32 s74, v16, 4
    v_readlane_b32 s75, v16, 5
    v_readlane_b32 s76, v16, 6
    v_readlane_b32 s77, v16, 7
    s_sub_u32 s70, s70, s73
    s_sub_u32 s73, s71, s72
    s_add_u32 s71, s70, s73
    s_sub_u32 s72, s70, s73
    s_add_u32 s73, s74, s75
    s_sub_u32 s73, s73, s76
    s_sub_u32 s73, s73, s77
    s_sub_u32 s74, s74, s75
    s_sub_u32 s76, s76, s77
    s_pack_ll_b32_b16 s71, s71, s72
    s_pack_ll_b32_b16 s74, s74, s76
    v_mov_b32 v16, s71
    v_mov_b32 v17, s74
    v_mov_b32 v18, s73
    s_lshl_b32 s81, s2, 4
    s_add_u32 s81, s81, 327680
    s_mov_b64 exec, 1
    buffer_store_dwordx3 v[16:18], off, s[52:55], s81 sc0 sc1
    s_waitcnt vmcnt(0)
    buffer_store_dword v120, off, s[52:55], s81 offset:12 sc0 sc1
    s_mov_b64 exec, -1
    s_mov_b32 s89, 400000
L_wm0:
    s_sleep 8
    ds_read_b32 v13, v118 offset:32
    s_sub_u32 s89, s89, 1
    s_waitcnt lgkmcnt(0)
    v_readfirstlane_b32 s81, v13
    s_cmp_eq_u32 s89, 0
    s_cbranch_scc1 L_wm0go
    s_cmp_lt_u32 s81, 4
    s_cbranch_scc1 L_wm0
L_wm0go:
    v_and_b32 v17, 7, v1
    v_lshlrev_b32 v17, 5, v17
    s_mov_b32 s89, 100000
    s_branch L_pa1
L_pa:
    s_sleep 64
L_pa1:
    buffer_load_dword v16, v17, s[56:59], 0 offen sc0 sc1
    s_sub_u32 s89, s89, 1
    s_waitcnt vmcnt(0)
    v_cmp_gt_u32 vcc, 32, v16
    s_cmp_eq_u32 s89, 0
    s_cbranch_scc1 L_pago
    s_cbranch_vccnz L_pa
L_pago:
    s_mov_b32 s81, 327680
    s_mov_b32 s89, 100000
    s_sleep 100
    s_branch L_pcc1
L_pcc:
    s_sleep 64
L_pcc1:
    buffer_load_dwordx4 v[16:19], v4, s[52:55], s81 offen offset:0 sc0 sc1
    buffer_load_dwordx4 v[20:23], v4, s[52:55], s81 offen offset:1024 sc0 sc1
    buffer_load_dwordx4 v[24:27], v4, s[52:55], s81 offen offset:2048 sc0 sc1
    buffer_load_dwordx4 v[28:31], v4, s[52:55], s81 offen offset:3072 sc0 sc1
    s_sub_u32 s89, s89, 1
    s_waitcnt vmcnt(0)
    v_xor_b32 v32, s50, v19
    v_xor_b32 v33, s50, v23
    v_xor_b32 v34, s50, v27
    v_xor_b32 v35, s50, v31
    v_or3_b32 v32, v32, v33, v34
    v_or_b32 v32, v32, v35
    v_cmp_ne_u32 vcc, 0, v32
    s_cmp_eq_u32 s89, 0
    s_cbranch_scc1 L_pccgo
    s_mov_b64 exec, vcc
    s_cbranch_vccnz L_pcc
L_pccgo:
    s_mov_b64 exec, -1
    v_bfe_i32 v32, v16, 0, 16
    v_ashrrev_i32 v16, 16, v16
    v_bfe_i32 v33, v20, 0, 16
    v_ashrrev_i32 v20, 16, v20
    v_bfe_i32 v34, v24, 0, 16
    v_ashrrev_i32 v24, 16, v24
    v_bfe_i32 v35, v28, 0, 16
    v_ashrrev_i32 v28, 16, v28
    v_add3_u32 v36, v32, v33, v34
    v_add_u32 v36, v36, v35
    v_bfe_i32 v32, v17, 0, 16
    v_ashrrev_i32 v17, 16, v17
    v_bfe_i32 v33, v21, 0, 16
    v_ashrrev_i32 v21, 16, v21
    v_bfe_i32 v34, v25, 0, 16
    v_ashrrev_i32 v25, 16, v25
    v_bfe_i32 v35, v29, 0, 16
    v_ashrrev_i32 v29, 16, v29
    v_add3_u32 v37, v32, v33, v34
    v_add_u32 v37, v37, v35
    v_add3_u32 v16, v16, v20, v24
    v_add_u32 v16, v16, v28
    v_add3_u32 v17, v17, v21, v25
    v_add_u32 v17, v17, v29
    v_add3_u32 v18, v18, v22, v26
    v_add_u32 v18, v18, v30
    v_add_u32_dpp v36, v36, v36 row_ror:1 row_mask:0xf bank_mask:0xf
    s_nop 1
    v_add_u32_dpp v36, v36, v36 row_ror:2 row_mask:0xf bank_mask:0xf
    s_nop 1
    v_add_u32_dpp v36, v36, v36 row_ror:4 row_mask:0xf bank_mask:0xf
    s_nop 1
    v_add_u32_dpp v36, v36, v36 row_ror:8 row_mask:0xf bank_mask:0xf
    v_mov_b32 v32, v36
    s_nop 1
    v_permlane16_swap_b32 v36, v32
    v_add_u32 v36, v36, v32
    v_mov_b32 v32, v36
    s_nop 1
    v_permlane32_swap_b32 v36, v32
    v_add_u32 v36, v36, v32
    v_add_u32_dpp v16, v16, v16 row_ror:1 row_mask:0xf bank_mask:0xf
    s_nop 1
    v_add_u32_dpp v16, v16, v16 row_ror:2 row_mask:0xf bank_mask:0xf
    s_nop 1
    v_add_u32_dpp v16, v16, v16 row_ror:4 row_mask:0xf bank_mask:0xf
    s_nop 1
    v_add_u32_dpp v16, v16, v16 row_ror:8 row_mask:0xf bank_mask:0xf
    v_mov_b32 v32, v16
    s_nop 1
    v_permlane16_swap_b32 v16, v32
    v_add_u32 v16, v16, v32
    v_mov_b32 v32, v16
    s_nop 1
    v_permlane32_swap_b32 v16, v32
    v_add_u32 v16, v16, v32
    v_add_u32_dpp v37, v37, v37 row_ror:1 row_mask:0xf bank_mask:0xf
    s_nop 1
    v_add_u32_dpp v37, v37, v37 row_ror:2 row_mask:0xf bank_mask:0xf
    s_nop 1
    v_add_u32_dpp v37, v37, v37 row_ror:4 row_mask:0xf bank_mask:0xf
    s_nop 1
    v_add_u32_dpp v37, v37, v37 row_ror:8 row_mask:0xf bank_mask:0xf
    v_mov_b32 v32, v37
    s_nop 1
    v_permlane16_swap_b32 v37, v32
    v_add_u32 v37, v37, v32
    v_mov_b32 v32, v37
    s_nop 1
    v_permlane32_swap_b32 v37, v32
    v_add_u32 v37, v37, v32
    v_add_u32_dpp v17, v17, v17 row_ror:1 row_mask:0xf bank_mask:0xf
    s_nop 1
    v_add_u32_dpp v17, v17, v17 row_ror:2 row_mask:0xf bank_mask:0xf
    s_nop 1
    v_add_u32_dpp v17, v17, v17 row_ror:4 row_mask:0xf bank_mask:0xf
    s_nop 1
    v_add_u32_dpp v17, v17, v17 row_ror:8 row_mask:0xf bank_mask:0xf
    v_mov_b32 v32, v17
    s_nop 1
    v_permlane16_swap_b32 v17, v32
    v_add_u32 v17, v17, v32
    v_mov_b32 v32, v17
    s_nop 1
    v_permlane32_swap_b32 v17, v32
    v_add_u32 v17, v17, v32
    v_add_u32_dpp v18, v18, v18 row_ror:1 row_mask:0xf bank_mask:0xf
    s_nop 1
    v_add_u32_dpp v18, v18, v18 row_ror:2 row_mask:0xf bank_mask:0xf
    s_nop 1
    v_add_u32_dpp v18, v18, v18 row_ror:4 row_mask:0xf bank_mask:0xf
    s_nop 1
    v_add_u32_dpp v18, v18, v18 row_ror:8 row_mask:0xf bank_mask:0xf
    v_mov_b32 v32, v18
    s_nop 1
    v_permlane16_swap_b32 v18, v32
    v_add_u32 v18, v18, v32
    v_mov_b32 v32, v18
    s_nop 1
    v_permlane32_swap_b32 v18, v32
    v_add_u32 v18, v18, v32
    v_readfirstlane_b32 s70, v36
    v_readfirstlane_b32 s71, v16
    v_readfirstlane_b32 s72, v37
    v_readfirstlane_b32 s73, v17
    v_readfirstlane_b32 s74, v18
    s_sub_u32 s70, s70, 5120
    s_xor_b32 s75, s70, s74
    s_lshr_b32 s75, s75, 31
    s_lshl_b32 s75, s75, 2
    s_add_u32 s76, s72, s73
    s_mul_i32 s71, s71, 4
    s_abs_i32 s77, s76
    s_mul_i32 s77, s77, 2
    s_add_u32 s71, s71, s77
    s_sub_u32 s71, s71, 200704
    s_xor_b32 s76, s76, s71
    s_lshr_b32 s76, s76, 31
    s_or_b32 s76, s76, s75
    s_cmp_lt_i32 s70, 0
    s_cselect_b32 s81, s75, 0
    s_xor_b32 s77, s48, s49
    s_or_b32 s81, s81, s77
    s_cselect_b32 s81, s76, 0
    s_mov_b32 s81, s76
    s_xor_b32 s49, s49, s81
    v_mov_b32 v13, s49
    ds_write_b32 v118, v13 offset:20
    s_xor_b32 s48, s48, s49
    s_lshr_b32 s81, s48, 2
    s_and_b32 s48, s48, 3
    s_lshl_b32 s48, s48, 1
    s_or_b32 s48, s48, s81
    s_xor_b32 s81, s2, s48
    s_lshl_b32 s44, s2, 7
    s_add_u32 s44, s44, 32768
    s_lshl_b32 s45, s81, 7
    s_add_u32 s45, s45, 32768
    s_lshl_b32 s46, s2, 12
    s_add_u32 s46, s46, 2097152
    s_lshl_b32 s47, s81, 12
    s_add_u32 s47, s47, 2097152
    s_cmp_eq_u32 s48, 0
    s_cbranch_scc1 L_nox1
    ds_read_b128 v[16:19], v4 offset:16384
    ds_read_b128 v[20:23], v4 offset:17408
    ds_read_b128 v[24:27], v4 offset:18432
    ds_read_b128 v[28:31], v4 offset:19456
    s_add_u32 s89, s46, 0
    s_waitcnt lgkmcnt(0)
    buffer_store_dwordx4 v[16:19], v4, s[52:55], s89 offen offset:0 sc0 sc1 nt
    buffer_store_dwordx4 v[20:23], v4, s[52:55], s89 offen offset:1024 sc0 sc1 nt
    buffer_store_dwordx4 v[24:27], v4, s[52:55], s89 offen offset:2048 sc0 sc1 nt
    buffer_store_dwordx4 v[28:31], v4, s[52:55], s89 offen offset:3072 sc0 sc1 nt
    s_waitcnt vmcnt(0)
    s_mov_b64 exec, 1
    buffer_store_dword v120, off, s[52:55], s44 offset:0 sc0 sc1
    s_mov_b64 exec, -1
L_nox1:
    s_cmp_lg_u32 s2, 0
    s_cbranch_scc1 L_noep
    s_mov_b64 exec, 1
    buffer_store_dword v120, off, s[52:55], s51 sc0 sc1
    s_mov_b64 exec, -1
L_noep:
    v_and_b32 v14, 7, v1
    v_lshlrev_b32 v14, 8, v14
    v_lshl_add_u32 v14, v6, 3, v14
    s_and_b32 s81, s2, -8
    s_lshl_b32 s81, s81, 8
    s_lshl_b32 s88, s5, 5
    s_add_u32 s81, s81, s88
    s_add_u32 s81, s81, 393216
    buffer_load_dwordx2 v[8:9], v14, s[52:55], s81 offen sc0 sc1
    v_lshlrev_b32 v16, 16, v156
    v_and_b32 v17, 0xffff0000, v156
    s_waitcnt vmcnt(0)
    v_add_f32_dpp v8, v8, v8 row_ror:1 row_mask:0xf bank_mask:0xf
    v_add_f32_dpp v9, v9, v9 row_ror:1 row_mask:0xf bank_mask:0xf
    s_nop 0
    v_add_f32_dpp v8, v8, v8 row_ror:2 row_mask:0xf bank_mask:0xf
    v_add_f32_dpp v9, v9, v9 row_ror:2 row_mask:0xf bank_mask:0xf
    s_nop 0
    v_add_f32_dpp v8, v8, v8 row_ror:4 row_mask:0xf bank_mask:0xf
    v_add_f32_dpp v9, v9, v9 row_ror:4 row_mask:0xf bank_mask:0xf
    v_cvt_pk_bf16_f32 v8, v8, v8
    v_and_b32 v8, 0xffff0000, v8
    v_add_f32 v8, v8, v16
    v_cvt_pk_bf16_f32 v8, v8, v8
    v_and_b32 v8, 0xffff0000, v8
    v_mul_f32 v20, v8, v8
    v_mul_f32 v20, 0x3d372713, v20
    v_fma_f32 v20, v20, v8, v8
    v_mul_f32 v20, 0xc0135761, v20
    v_exp_f32 v20, v20
    s_nop 0
    v_add_f32 v20, 1.0, v20
    v_rcp_f32 v20, v20
    s_nop 0
    v_mul_f32 v8, v8, v20
    v_cvt_pk_bf16_f32 v24, v8, v8
    v_cvt_pk_bf16_f32 v9, v9, v9
    v_and_b32 v9, 0xffff0000, v9
    v_add_f32 v9, v9, v17
    v_cvt_pk_bf16_f32 v9, v9, v9
    v_and_b32 v9, 0xffff0000, v9
    v_mul_f32 v20, v9, v9
    v_mul_f32 v20, 0x3d372713, v20
    v_fma_f32 v20, v20, v9, v9
    v_mul_f32 v20, 0xc0135761, v20
    v_exp_f32 v20, v20
    s_nop 0
    v_add_f32 v20, 1.0, v20
    v_rcp_f32 v20, v20
    s_nop 0
    v_mul_f32 v9, v9, v20
    v_cvt_pk_bf16_f32 v25, v9, v9
    v_and_b32 v12, 7, v1
    v_lshrrev_b32 v13, 1, v12
    v_and_b32 v12, 1, v12
    v_cmp_eq_u32 vcc, 1, v12
    v_mov_b32 v12, 0xffff
    v_mov_b32 v14, 0xffff0000
    v_cndmask_b32 v12, v12, v14, vcc
    v_cmp_eq_u32 vcc, 0, v13
    s_nop 1
    v_cndmask_b32 v8, 0, v12, vcc
    v_cmp_eq_u32 vcc, 1, v13
    s_nop 1
    v_cndmask_b32 v9, 0, v12, vcc
    v_cmp_eq_u32 vcc, 2, v13
    s_nop 1
    v_cndmask_b32 v10, 0, v12, vcc
    v_cmp_eq_u32 vcc, 3, v13
    s_nop 1
    v_cndmask_b32 v11, 0, v12, vcc
    v_and_b32 v16, v24, v8
    v_and_b32 v17, v24, v9
    v_and_b32 v18, v24, v10
    v_and_b32 v19, v24, v11
    v_and_b32 v20, v25, v8
    v_and_b32 v21, v25, v9
    v_and_b32 v22, v25, v10
    v_and_b32 v23, v25, v11
    v_mfma_f32_16x16x32_bf16 v[96:99], v[16:19], v[124:127], 0
    v_mfma_f32_16x16x32_bf16 v[100:103], v[16:19], v[128:131], 0
    v_mfma_f32_16x16x32_bf16 v[104:107], v[16:19], v[132:135], 0
    v_mfma_f32_16x16x32_bf16 v[108:111], v[16:19], v[136:139], 0
    v_mfma_f32_16x16x32_bf16 v[96:99], v[20:23], v[140:143], v[96:99]
    v_mfma_f32_16x16x32_bf16 v[100:103], v[20:23], v[144:147], v[100:103]
    v_mfma_f32_16x16x32_bf16 v[104:107], v[20:23], v[148:151], v[104:107]
    v_mfma_f32_16x16x32_bf16 v[108:111], v[20:23], v[152:155], v[108:111]
    v_and_b32 v3, 1, v6
    v_lshlrev_b32 v3, 4, v3
    v_lshl_add_u32 v3, v7, 13, v3
    s_lshl_b32 s80, s7, 3
    s_add_u32 s80, s80, s4
    s_lshl_b32 s80, s80, 5
    s_add_u32 s80, s80, 524288
    s_cmp_eq_u32 s48, 0
    s_cbranch_scc1 L_nox2
    s_mov_b32 s89, 100000
L_pr0:
    s_sleep 48
L_pr01:
    buffer_load_dword v16, off, s[52:55], s45 offset:0 sc0 sc1
    s_sub_u32 s89, s89, 1
    s_waitcnt vmcnt(0)
    v_cmp_ne_u32 vcc, s50, v16
    s_cmp_eq_u32 s89, 0
    s_cbranch_scc1 L_pr0go
    s_cbranch_vccnz L_pr0
L_pr0go:
    s_add_u32 s89, s47, 0
    buffer_load_dwordx4 v[16:19], v4, s[52:55], s89 offen offset:0 sc0 sc1 nt
    buffer_load_dwordx4 v[20:23], v4, s[52:55], s89 offen offset:1024 sc0 sc1 nt
    buffer_load_dwordx4 v[24:27], v4, s[52:55], s89 offen offset:2048 sc0 sc1 nt
    buffer_load_dwordx4 v[28:31], v4, s[52:55], s89 offen offset:3072 sc0 sc1 nt
    s_waitcnt vmcnt(0)
    ds_write_b128 v4, v[16:19] offset:24576
    ds_write_b128 v4, v[20:23] offset:25600
    ds_write_b128 v4, v[24:27] offset:26624
    ds_write_b128 v4, v[28:31] offset:27648
    s_waitcnt lgkmcnt(0)
    ds_write_b32 v118, v119 offset:40
    s_mov_b32 s89, 400000
L_wm1:
    s_sleep 8
    ds_read_b32 v13, v118 offset:36
    s_sub_u32 s89, s89, 1
    s_waitcnt lgkmcnt(0)
    v_readfirstlane_b32 s81, v13
    s_cmp_eq_u32 s89, 0
    s_cbranch_scc1 L_wm1go
    s_cmp_lt_u32 s81, 4
    s_cbranch_scc1 L_wm1
L_wm1go:
    ds_read_b128 v[16:19], v4 offset:20480
    ds_read_b128 v[20:23], v4 offset:21504
    ds_read_b128 v[24:27], v4 offset:22528
    ds_read_b128 v[28:31], v4 offset:23552
    s_add_u32 s89, s46, 1048576
    s_waitcnt lgkmcnt(0)
    buffer_store_dwordx4 v[16:19], v4, s[52:55], s89 offen offset:0 sc0 sc1 nt
    buffer_store_dwordx4 v[20:23], v4, s[52:55], s89 offen offset:1024 sc0 sc1 nt
    buffer_store_dwordx4 v[24:27], v4, s[52:55], s89 offen offset:2048 sc0 sc1 nt
    buffer_store_dwordx4 v[28:31], v4, s[52:55], s89 offen offset:3072 sc0 sc1 nt
    s_waitcnt vmcnt(0)
    s_mov_b64 exec, 1
    buffer_store_dword v120, off, s[52:55], s44 offset:4 sc0 sc1
    s_mov_b64 exec, -1
    s_mov_b32 s89, 100000
L_pr1:
    s_sleep 48
L_pr11:
    buffer_load_dword v16, off, s[52:55], s45 offset:4 sc0 sc1
    s_sub_u32 s89, s89, 1
    s_waitcnt vmcnt(0)
    v_cmp_ne_u32 vcc, s50, v16
    s_cmp_eq_u32 s89, 0
    s_cbranch_scc1 L_pr1go
    s_cbranch_vccnz L_pr1
L_pr1go:
    s_add_u32 s89, s47, 1048576
    buffer_load_dwordx4 v[16:19], v4, s[52:55], s89 offen offset:0 sc0 sc1 nt
    buffer_load_dwordx4 v[20:23], v4, s[52:55], s89 offen offset:1024 sc0 sc1 nt
    buffer_load_dwordx4 v[24:27], v4, s[52:55], s89 offen offset:2048 sc0 sc1 nt
    buffer_load_dwordx4 v[28:31], v4, s[52:55], s89 offen offset:3072 sc0 sc1 nt
    s_waitcnt vmcnt(0)
    ds_write_b128 v4, v[16:19] offset:28672
    ds_write_b128 v4, v[20:23] offset:29696
    ds_write_b128 v4, v[24:27] offset:30720
    ds_write_b128 v4, v[28:31] offset:31744
    s_waitcnt lgkmcnt(0)
    ds_write_b32 v118, v119 offset:44
L_nox2:
    v_lshrrev_b32 v12, 1, v6
    v_lshlrev_b32 v12, 10, v12
    v_lshl_add_u32 v12, v7, 5, v12
    v_and_b32 v13, 1, v6
    v_lshl_add_u32 v12, v13, 4, v12
    v_lshrrev_b32 v13, 5, v1
    v_lshlrev_b32 v14, 4, v13
    v_lshlrev_b32 v13, 2, v13
    v_add_u32 v13, 12288, v13
    v_lshlrev_b32 v15, 12, v7
    v_lshl_add_u32 v15, v6, 4, v15
    s_lshl_b32 s85, s4, 17
    s_add_u32 s85, s85, 1048576
    s_lshl_b32 s86, s7, 6
    s_add_u32 s85, s85, s86
    s_add_u32 s86, s85, 0x10000
    s_mov_b32 s84, 0x3db8aa3b
    s_mov_b32 s89, 400000
L_wn:
    s_sleep 8
    ds_read_b32 v16, v118 offset:28
    s_sub_u32 s89, s89, 1
    s_waitcnt lgkmcnt(0)
    v_readfirstlane_b32 s81, v16
    s_cmp_eq_u32 s89, 0
    s_cbranch_scc1 L_wngo
    s_cmp_lt_u32 s81, 4
    s_cbranch_scc1 L_wn
L_wngo:
    ds_read2_b32 v[16:17], v13 offset0:0 offset1:2
    ds_read2_b32 v[18:19], v13 offset0:4 offset1:6
    ds_read2_b32 v[20:21], v13 offset0:8 offset1:10
    ds_read2_b32 v[22:23], v13 offset0:12 offset1:14
    s_waitcnt lgkmcnt(0)
    v_max3_f32 v24, v16, v18, v20
    v_max_f32 v24, v24, v22
    v_sub_f32 v28, v16, v24
    v_sub_f32 v29, v18, v24
    v_sub_f32 v30, v20, v24
    v_sub_f32 v31, v22, v24
    v_mul_f32 v28, s84, v28
    v_mul_f32 v29, s84, v29
    v_mul_f32 v30, s84, v30
    v_mul_f32 v31, s84, v31
    v_exp_f32 v28, v28
    v_exp_f32 v29, v29
    v_exp_f32 v30, v30
    v_exp_f32 v31, v31
    v_mul_f32 v26, v28, v17
    v_fmac_f32 v26, v29, v19
    v_fmac_f32 v26, v30, v21
    v_fmac_f32 v26, v31, v23
    v_mov_b32 v25, s50
    v_mov_b32 v27, s50
    s_lshl_b32 s88, s2, 5
    s_add_u32 s88, s88, 24576
    s_mov_b32 exec_lo, 1
    s_mov_b32 exec_hi, 1
    buffer_store_dwordx4 v[24:27], v14, s[52:55], s88 offen sc0 sc1
    s_mov_b64 exec, -1
    v_and_b32 v32, 31, v1
    v_lshl_add_u32 v32, v32, 5, v14
    s_lshl_b32 s88, s4, 10
    s_add_u32 s88, s88, 24576
    s_mov_b32 s89, 100000
    s_sleep 112
    s_branch L_pn1
L_pn:
    s_sleep 48
L_pn1:
    buffer_load_dwordx4 v[36:39], v32, s[52:55], s88 offen sc0 sc1
    s_sub_u32 s89, s89, 1
    s_waitcnt vmcnt(0)
    v_xor_b32 v37, s50, v37
    v_xor_b32 v39, s50, v39
    v_or_b32 v37, v37, v39
    v_cmp_ne_u32 vcc, 0, v37
    s_cmp_eq_u32 s89, 0
    s_cbranch_scc1 L_pngo
    s_cbranch_vccnz L_pn
L_pngo:
    v_mov_b32 v40, v36
    s_nop 1
    v_max_f32_dpp v40, v40, v40 row_ror:1 row_mask:0xf bank_mask:0xf
    s_nop 1
    v_max_f32_dpp v40, v40, v40 row_ror:2 row_mask:0xf bank_mask:0xf
    s_nop 1
    v_max_f32_dpp v40, v40, v40 row_ror:4 row_mask:0xf bank_mask:0xf
    s_nop 1
    v_max_f32_dpp v40, v40, v40 row_ror:8 row_mask:0xf bank_mask:0xf
    v_mov_b32 v41, v40
    s_nop 1
    v_permlane16_swap_b32 v40, v41
    v_max_f32 v40, v40, v41
    v_sub_f32 v36, v36, v40
    v_mul_f32 v36, s84, v36
    v_exp_f32 v36, v36
    s_nop 0
    v_mul_f32 v36, v36, v38
    s_nop 1
    v_add_f32_dpp v36, v36, v36 row_ror:1 row_mask:0xf bank_mask:0xf
    s_nop 1
    v_add_f32_dpp v36, v36, v36 row_ror:2 row_mask:0xf bank_mask:0xf
    s_nop 1
    v_add_f32_dpp v36, v36, v36 row_ror:4 row_mask:0xf bank_mask:0xf
    s_nop 1
    v_add_f32_dpp v36, v36, v36 row_ror:8 row_mask:0xf bank_mask:0xf
    v_mov_b32 v41, v36
    s_nop 1
    v_permlane16_swap_b32 v36, v41
    v_add_f32 v36, v36, v41
    v_rcp_f32 v36, v36
    v_sub_f32 v24, v24, v40
    v_mul_f32 v24, s84, v24
    v_exp_f32 v24, v24
    s_nop 0
    v_mul_f32 v24, v24, v36
    v_mul_f32 v116, v28, v24
    v_mul_f32 v117, v29, v24
    v_mul_f32 v118, v30, v24
    v_mul_f32 v119, v31, v24
    s_mov_b32 s54, 0
    s_mov_b32 s62, 0
    s_mov_b32 s79, s80
    s_branch L_tail
L_tail2:
    s_mov_b32 s54, 16777216
    s_mov_b32 s62, 896
    s_mov_b32 s80, s79
    s_barrier
L_tail:
    ds_read_b128 v[32:35], v4 offset:4096
    ds_read_b128 v[36:39], v4 offset:5120
    ds_read_b128 v[40:43], v4 offset:6144
    ds_read_b128 v[44:47], v4 offset:7168
    ds_read_b128 v[48:51], v4 offset:8192
    ds_read_b128 v[52:55], v4 offset:9216
    ds_read_b128 v[56:59], v4 offset:10240
    ds_read_b128 v[60:63], v4 offset:11264
    s_waitcnt lgkmcnt(6)
    v_mul_f32 v32, v116, v32
    v_mul_f32 v33, v116, v33
    v_mul_f32 v34, v116, v34
    v_mul_f32 v35, v116, v35
    v_mul_f32 v36, v116, v36
    v_mul_f32 v37, v116, v37
    v_mul_f32 v38, v116, v38
    v_mul_f32 v39, v116, v39
    s_waitcnt lgkmcnt(4)
    v_fmac_f32 v32, v117, v40
    v_fmac_f32 v33, v117, v41
    v_fmac_f32 v34, v117, v42
    v_fmac_f32 v35, v117, v43
    v_fmac_f32 v36, v117, v44
    v_fmac_f32 v37, v117, v45
    v_fmac_f32 v38, v117, v46
    v_fmac_f32 v39, v117, v47
    s_waitcnt lgkmcnt(2)
    v_fmac_f32 v32, v118, v48
    v_fmac_f32 v33, v118, v49
    v_fmac_f32 v34, v118, v50
    v_fmac_f32 v35, v118, v51
    v_fmac_f32 v36, v118, v52
    v_fmac_f32 v37, v118, v53
    v_fmac_f32 v38, v118, v54
    v_fmac_f32 v39, v118, v55
    s_waitcnt lgkmcnt(0)
    v_fmac_f32 v32, v119, v56
    v_fmac_f32 v33, v119, v57
    v_fmac_f32 v34, v119, v58
    v_fmac_f32 v35, v119, v59
    v_fmac_f32 v36, v119, v60
    v_fmac_f32 v37, v119, v61
    v_fmac_f32 v38, v119, v62
    v_fmac_f32 v39, v119, v63
    buffer_store_dwordx4 v[32:35], v12, s[52:55], s82 offen sc0 sc1
    buffer_store_dwordx4 v[36:39], v12, s[52:55], s82 offen offset:512 sc0 sc1
    s_mov_b32 s89, 100000
    s_sleep 8
    s_branch L_pp1
L_pp:
L_pp1:
    buffer_load_dwordx4 v[40:43], v15, s[52:55], s85 offen sc0 sc1
    buffer_load_dwordx4 v[44:47], v15, s[52:55], s86 offen sc0 sc1
    s_sub_u32 s89, s89, 1
    s_waitcnt vmcnt(0)
    v_max3_u32 v52, v40, v41, v42
    v_max3_u32 v53, v43, v44, v45
    v_max3_u32 v52, v52, v46, v47
    v_max_u32 v52, v52, v53
    v_cmp_eq_u32 vcc, -1, v52
    s_cmp_eq_u32 s89, 0
    s_cbranch_scc1 L_ppgo
    s_mov_b64 exec, vcc
    s_cbranch_vccnz L_pp
L_ppgo:
    s_mov_b64 exec, -1
    v_add_f32 v40, v40, v44
    v_add_f32 v41, v41, v45
    v_add_f32 v42, v42, v46
    v_add_f32 v43, v43, v47
    v_add_f32_dpp v40, v40, v40 row_ror:1 row_mask:0xf bank_mask:0xf
    v_add_f32_dpp v41, v41, v41 row_ror:1 row_mask:0xf bank_mask:0xf
    v_add_f32_dpp v42, v42, v42 row_ror:1 row_mask:0xf bank_mask:0xf
    v_add_f32_dpp v43, v43, v43 row_ror:1 row_mask:0xf bank_mask:0xf
    v_add_f32_dpp v40, v40, v40 row_ror:2 row_mask:0xf bank_mask:0xf
    v_add_f32_dpp v41, v41, v41 row_ror:2 row_mask:0xf bank_mask:0xf
    v_add_f32_dpp v42, v42, v42 row_ror:2 row_mask:0xf bank_mask:0xf
    v_add_f32_dpp v43, v43, v43 row_ror:2 row_mask:0xf bank_mask:0xf
    v_add_f32_dpp v40, v40, v40 row_ror:4 row_mask:0xf bank_mask:0xf
    v_add_f32_dpp v41, v41, v41 row_ror:4 row_mask:0xf bank_mask:0xf
    v_add_f32_dpp v42, v42, v42 row_ror:4 row_mask:0xf bank_mask:0xf
    v_add_f32_dpp v43, v43, v43 row_ror:4 row_mask:0xf bank_mask:0xf
    v_add_f32_dpp v40, v40, v40 row_ror:8 row_mask:0xf bank_mask:0xf
    v_add_f32_dpp v41, v41, v41 row_ror:8 row_mask:0xf bank_mask:0xf
    v_add_f32_dpp v42, v42, v42 row_ror:8 row_mask:0xf bank_mask:0xf
    v_add_f32_dpp v43, v43, v43 row_ror:8 row_mask:0xf bank_mask:0xf
    v_cvt_pk_bf16_f32 v40, v40, v40
    v_cvt_pk_bf16_f32 v41, v41, v41
    v_cvt_pk_bf16_f32 v42, v42, v42
    v_cvt_pk_bf16_f32 v43, v43, v43
    v_and_b32 v64, v40, v8
    v_and_b32 v65, v40, v9
    v_and_b32 v66, v40, v10
    v_and_b32 v67, v40, v11
    v_and_b32 v68, v41, v8
    v_and_b32 v69, v41, v9
    v_and_b32 v70, v41, v10
    v_and_b32 v71, v41, v11
    v_and_b32 v72, v42, v8
    v_and_b32 v73, v42, v9
    v_and_b32 v74, v42, v10
    v_and_b32 v75, v42, v11
    v_and_b32 v76, v43, v8
    v_and_b32 v77, v43, v9
    v_and_b32 v78, v43, v10
    v_and_b32 v79, v43, v11
    v_mfma_f32_16x16x32_bf16 v[96:99], v[64:67], v[160:163], v[96:99]
    v_mfma_f32_16x16x32_bf16 v[96:99], v[68:71], v[176:179], v[96:99]
    v_mfma_f32_16x16x32_bf16 v[96:99], v[72:75], v[192:195], v[96:99]
    v_mfma_f32_16x16x32_bf16 v[96:99], v[76:79], v[208:211], v[96:99]
    v_mfma_f32_16x16x32_bf16 v[100:103], v[64:67], v[164:167], v[100:103]
    v_mfma_f32_16x16x32_bf16 v[100:103], v[68:71], v[180:183], v[100:103]
    v_mfma_f32_16x16x32_bf16 v[100:103], v[72:75], v[196:199], v[100:103]
    v_mfma_f32_16x16x32_bf16 v[100:103], v[76:79], v[212:215], v[100:103]
    v_mfma_f32_16x16x32_bf16 v[104:107], v[64:67], v[168:171], v[104:107]
    v_mfma_f32_16x16x32_bf16 v[104:107], v[68:71], v[184:187], v[104:107]
    v_mfma_f32_16x16x32_bf16 v[104:107], v[72:75], v[200:203], v[104:107]
    v_mfma_f32_16x16x32_bf16 v[104:107], v[76:79], v[216:219], v[104:107]
    v_mfma_f32_16x16x32_bf16 v[108:111], v[64:67], v[172:175], v[108:111]
    v_mfma_f32_16x16x32_bf16 v[108:111], v[68:71], v[188:191], v[108:111]
    v_mfma_f32_16x16x32_bf16 v[108:111], v[72:75], v[204:207], v[108:111]
    v_mfma_f32_16x16x32_bf16 v[108:111], v[76:79], v[220:223], v[108:111]
    s_mov_b32 exec_hi, 0
    buffer_store_dwordx4 v[96:99], v3, s[52:55], s80 offen sc0 sc1
    s_add_u32 s80, s80, 131072
    buffer_store_dwordx4 v[100:103], v3, s[52:55], s80 offen sc0 sc1
    s_add_u32 s80, s80, 131072
    buffer_store_dwordx4 v[104:107], v3, s[52:55], s80 offen sc0 sc1
    s_add_u32 s80, s80, 131072
    s_nop 0
    buffer_store_dwordx4 v[108:111], v3, s[52:55], s80 offen sc0 sc1
    s_add_u32 s80, s80, 131072
    s_mov_b32 exec_hi, -1
    s_cmp_ge_u32 s2, 56
    s_cbranch_scc1 L_hdone
    s_add_u32 s81, s83, 4096
    s_mov_b32 s89, 100000
    s_sleep 16
    s_branch L_py1
L_py:
L_py1:
    buffer_load_dwordx4 v[16:19], v4, s[52:55], s83 offen offset:0 sc0 sc1
    buffer_load_dwordx4 v[20:23], v4, s[52:55], s83 offen offset:1024 sc0 sc1
    buffer_load_dwordx4 v[24:27], v4, s[52:55], s83 offen offset:2048 sc0 sc1
    buffer_load_dwordx4 v[28:31], v4, s[52:55], s83 offen offset:3072 sc0 sc1
    buffer_load_dwordx4 v[32:35], v4, s[52:55], s81 offen offset:0 sc0 sc1
    buffer_load_dwordx4 v[36:39], v4, s[52:55], s81 offen offset:1024 sc0 sc1
    buffer_load_dwordx4 v[40:43], v4, s[52:55], s81 offen offset:2048 sc0 sc1
    buffer_load_dwordx4 v[44:47], v4, s[52:55], s81 offen offset:3072 sc0 sc1
    s_sub_u32 s89, s89, 1
    s_waitcnt vmcnt(0)
    v_max3_u32 v60, v16, v17, v18
    v_max3_u32 v61, v19, v20, v21
    v_max3_u32 v60, v60, v22, v23
    v_max3_u32 v61, v61, v24, v25
    v_max3_u32 v60, v60, v26, v27
    v_max3_u32 v61, v61, v28, v29
    v_max3_u32 v60, v60, v30, v31
    v_max3_u32 v61, v61, v32, v33
    v_max3_u32 v60, v60, v34, v35
    v_max3_u32 v61, v61, v36, v37
    v_max3_u32 v60, v60, v38, v39
    v_max3_u32 v61, v61, v40, v41
    v_max3_u32 v60, v60, v42, v43
    v_max3_u32 v61, v61, v44, v45
    v_max3_u32 v60, v60, v46, v47
    v_max_u32 v60, v60, v61
    v_cmp_eq_u32 vcc, -1, v60
    s_cmp_eq_u32 s89, 0
    s_cbranch_scc1 L_pygo
    s_mov_b64 exec, vcc
    s_cbranch_vccnz L_py
L_pygo:
    s_mov_b64 exec, -1
    v_add_f32 v16, v16, v32
    v_add_f32 v17, v17, v33
    v_add_f32 v18, v18, v34
    v_add_f32 v19, v19, v35
    v_add_f32 v20, v20, v36
    v_add_f32 v21, v21, v37
    v_add_f32 v22, v22, v38
    v_add_f32 v23, v23, v39
    v_add_f32 v24, v24, v40
    v_add_f32 v25, v25, v41
    v_add_f32 v26, v26, v42
    v_add_f32 v27, v27, v43
    v_add_f32 v28, v28, v44
    v_add_f32 v29, v29, v45
    v_add_f32 v30, v30, v46
    v_add_f32 v31, v31, v47
    v_add_f32 v16, v16, v24
    v_add_f32 v17, v17, v25
    v_add_f32 v18, v18, v26
    v_add_f32 v19, v19, v27
    v_add_f32 v20, v20, v28
    v_add_f32 v21, v21, v29
    v_add_f32 v22, v22, v30
    v_add_f32 v23, v23, v31
    v_add_f32 v16, v16, v20
    v_add_f32 v17, v17, v21
    v_add_f32 v18, v18, v22
    v_add_f32 v19, v19, v23
    v_permlane16_swap_b32 v16, v17
    s_nop 0
    v_permlane16_swap_b32 v18, v19
    v_add_f32 v16, v16, v17
    v_add_f32 v18, v18, v19
    s_nop 1
    v_permlane32_swap_b32 v16, v18
    v_add_f32 v16, v16, v18
    s_nop 1
    v_add_f32_dpp v16, v16, v16 row_ror:2 row_mask:0xf bank_mask:0xf
    s_nop 1
    v_add_f32_dpp v16, v16, v16 row_ror:4 row_mask:0xf bank_mask:0xf
    s_nop 1
    v_add_f32_dpp v16, v16, v16 row_ror:8 row_mask:0xf bank_mask:0xf
    v_add_f32 v16, v113, v16
    v_cvt_pk_bf16_f32 v16, v16, v16
    s_mov_b32 exec_lo, 196611
    s_mov_b32 exec_hi, 196611
    buffer_store_short v16, v159, s[60:63], s87 offen
    s_mov_b64 exec, -1
L_hdone:
    s_cmp_eq_u32 s54, 0
    s_cbranch_scc1 L_tail2
L_end:
    s_endpgm
L_codeend:
.section .rodata,"a"
.p2align 6
.amdhsa_kernel parallel_sum__gqa_block_cached__dense_activation_gelu__decode_kernel
  .amdhsa_next_free_vgpr 224
  .amdhsa_next_free_sgpr 96
  .amdhsa_accum_offset 224
  .amdhsa_group_segment_fixed_size 0
  .amdhsa_kernarg_size 104
  .amdhsa_user_sgpr_count 2
  .amdhsa_user_sgpr_kernarg_segment_ptr 1
  .amdhsa_system_sgpr_workgroup_id_x 1
  .amdhsa_float_denorm_mode_32 3
.end_amdhsa_kernel
```
